```python
import torch

def _softmax(x, axis=-1):
    return torch.softmax(x, dim=axis)
def _gelu(x):
    return torch.nn.functional.gelu(x, approximate="tanh")
def _silu(x):
    return torch.nn.functional.silu(x)
def _sigmoid(x):
    return torch.sigmoid(x)
def _layernorm(x, axis=-1, eps=1e-5):
    m = x.mean(dim=axis, keepdim=True)
    v = x.var(dim=axis, keepdim=True, unbiased=False)
    return (x - m) / torch.sqrt(v + eps)
def _scatter_add(tgt, idx, src, axis=0):
    return tgt.clone().index_add_(axis, idx, src)
def _segment_sum(src, seg, n):
    out = torch.zeros((n,) + src.shape[1:], dtype=src.dtype)
    return out.index_add_(0, seg, src)
def _pad(x, pw):
    flat = tuple(v for pair in reversed(pw) for v in pair)
    return torch.nn.functional.pad(x, flat)

kernel_name = 'gated_mix__linear_attn_block__glu_gated_swiglu__prompt'

def setup_inputs():

    _w = (lambda a: (lambda t: t.to(torch.bfloat16) if t.is_floating_point() else t)(torch.as_tensor(a)))
    def _A_setup():
        B, S, D = 1, 2048, 448
        return {
            "x": _w((lambda *s: torch.randn(*s, dtype=torch.bfloat16) * 0.05)(B, S, D)),
            "wqkv": _w((lambda *s: torch.randn(*s, dtype=torch.bfloat16) * 0.8)(D, 3 * D)),
            "wo": _w((lambda *s: torch.randn(*s, dtype=torch.bfloat16) * 0.05)(D, D)),
        }
    _A_in = _A_setup()

    def _B_setup():
        B, S, D, F = 1, 2048, 448, 1792
        return {
            "x": _w((lambda *s: torch.randn(*s, dtype=torch.bfloat16) * 0.05)(B, S, D)),
            "w1": _w((lambda *s: torch.randn(*s, dtype=torch.bfloat16) * 1.6)(D, F) * (2.0 / D) ** 0.5),
            "w3": _w((lambda *s: torch.randn(*s, dtype=torch.bfloat16) * 1.6)(D, F) * (2.0 / D) ** 0.5),
            "w2": _w((lambda *s: torch.randn(*s, dtype=torch.bfloat16) * 1.6)(F, D) * (2.0 / F) ** 0.5),
        }
    _B_in = _B_setup()

    return {
        "A_x": _A_in["x"],
        "A_wqkv": _A_in["wqkv"],
        "A_wo": _A_in["wo"],
        "B_x": _B_in["x"],
        "B_w1": _B_in["w1"],
        "B_w3": _B_in["w3"],
        "B_w2": _B_in["w2"],
        "gate_w": _w((lambda *s: torch.randn(*s, dtype=torch.bfloat16) * 0.05)(448) * 16.0),
    }

def reference(A_x, A_wqkv, A_wo, B_x, B_w1, B_w3, B_w2, gate_w):
    def _A_ref(x, wqkv, wo):
        B, S, D = x.shape
        H = 16; Dh = D // H
        qkv = (lambda x, *d: x.permute(*d))((x @ wqkv).reshape(B, S, 3, H, Dh), 2, 0, 3, 1, 4)
        q, k, v = qkv[0], qkv[1], qkv[2]
        phi = lambda t: torch.where(t > 0, t + 1, torch.exp(t)) + 1e-6
        pq, pk = phi(q), phi(k)
        kv = torch.einsum("bhsd,bhse->bhde", pk, v)
        z = torch.einsum("bhsd->bhd", pk)
        num = torch.einsum("bhqd,bhde->bhqe", pq, kv)
        den = torch.einsum("bhqd,bhd->bhq", pq, z)[..., None] + 1e-6
        o = num / den
        return (lambda x, *d: x.permute(*d))(o, 0, 2, 1, 3).reshape(B, S, D) @ wo

    def _B_ref(x, w1, w3, w2):
        gate = torch.einsum("bsd,df->bsf", x, w1)
        up = torch.einsum("bsd,df->bsf", x, w3)
        h = _silu(gate) * up
        out = torch.einsum("bsf,fd->bsd", h, w2)
        return out

    x = A_x
    g = _sigmoid((x * gate_w).sum(-1, keepdims=True))
    a = _A_ref(x, A_wqkv, A_wo)
    b = _B_ref(x, B_w1, B_w3, B_w2)
    return g * a + (1 - g) * b
```

```asm
; @launch kernel=k1_kernel grid=(256,1,1) block=(512,1,1) lds=114688
; @launch kernel=k2_kernel grid=(240,1,1) block=(256,1,1) lds=131072
.amdgcn_target "amdgcn-amd-amdhsa--gfx950"
.text
.globl k1_kernel
.p2align 8
.type k1_kernel,@function
k1_kernel:
    s_cmp_ge_u32 s2, 256
    s_cbranch_scc1 K1_END
    s_load_dwordx4 s[4:7], s[0:1], 0
    s_load_dwordx4 s[8:11], s[0:1], 32
    s_load_dwordx2 s[12:13], s[0:1], 56
    s_load_dwordx2 s[14:15], s[0:1], 80
    s_load_dwordx2 s[96:97], s[0:1], 48
    s_load_dwordx2 s[98:99], s[0:1], 16
    s_getpc_b64 s[100:101]
K1_PC:
    s_sub_u32 s100, s100, K1_PC-k1_kernel
    s_subb_u32 s101, s101, 0
    v_lshlrev_b32 v24, 7, v0
    v_min_u32 v24, K2_END-k1_kernel, v24
    global_load_dword v211, v24, s[100:101]
    v_and_b32 v1, 63, v0
    v_lshrrev_b32 v24, 6, v0
    s_nop 0
    v_readfirstlane_b32 s50, v24
    s_mov_b32 s60, 0xffff0000
    s_mov_b32 s62, 0xbfb8aa3b
    s_mov_b32 s63, 0xbfb8aa3b
    s_mov_b32 s64, 1.0
    s_mov_b32 s65, 1.0
    s_mov_b32 s66, 0x3fb8aa3b
    s_mov_b32 s67, 0x358637bd
    s_and_b32 s52, s2, 7
    s_lshr_b32 s75, s2, 3
    s_and_b32 s54, s52, 3
    s_lshl_b32 s54, s54, 2
    s_and_b32 s55, s75, 3
    s_add_u32 s48, s54, s55
    s_lshr_b32 s54, s52, 2
    s_lshl_b32 s54, s54, 3
    s_lshr_b32 s74, s75, 2
    s_add_u32 s49, s54, s74
    s_and_b32 s51, s50, 1
    s_and_b32 s57, s48, 1
    s_lshr_b32 s56, s48, 1
    s_lshl_b32 s58, s49, 3
    s_lshl_b32 s52, s51, 2
    s_add_u32 s58, s58, s52
    s_waitcnt lgkmcnt(0)
    s_mov_b32 s16, s4
    s_and_b32 s17, s5, 0xffff
    s_mov_b32 s18, 0x1c0000
    s_mov_b32 s19, 0x00020000
    s_mov_b32 s20, s14
    s_and_b32 s21, s15, 0xffff
    s_mov_b32 s22, 0xb20000
    s_mov_b32 s23, 0x00020000
    s_mov_b32 s24, s12
    s_and_b32 s25, s13, 0xffff
    s_mov_b32 s26, 0x380
    s_mov_b32 s27, 0x00020000
    s_lshl_b32 s52, s49, 7
    s_lshl_b32 s53, s48, 3
    s_add_u32 s52, s52, s53
    s_add_u32 s52, s52, s50
    s_mul_i32 s53, s52, 896
    v_lshlrev_b32 v24, 4, v1
    v_mov_b32 v25, 0x7ffffff0
    v_cmp_gt_u32 vcc, 56, v1
    s_nop 1
    v_cndmask_b32 v24, v25, v24, vcc
    buffer_load_dwordx4 v[96:99], v24, s[16:19], s53 offen
    buffer_load_dwordx4 v[100:103], v24, s[24:27], 0 offen
    s_lshl_b32 s59, s52, 2
    s_cmp_eq_u32 s57, 0
    s_cselect_b32 s28, s6, s8
    s_cselect_b32 s29, s7, s9
    s_mov_b32 s55, 0x126000
    s_cselect_b32 s30, s55, 0x188000
    s_and_b32 s29, s29, 0xffff
    s_mov_b32 s31, 0x00020000
    s_cmp_eq_u32 s57, 0
    s_cselect_b32 s32, s6, s8
    s_cselect_b32 s33, s7, s9
    s_mov_b32 s55, 0x126000
    s_cselect_b32 s34, s55, 0x188000
    s_and_b32 s33, s33, 0xffff
    s_mov_b32 s35, 0x00020000
    s_cmp_eq_u32 s57, 0
    s_cselect_b32 s36, s6, s10
    s_cselect_b32 s37, s7, s11
    s_mov_b32 s55, 0x126000
    s_cselect_b32 s38, s55, 0x188000
    s_and_b32 s37, s37, 0xffff
    s_mov_b32 s39, 0x00020000
    s_cmp_eq_u32 s57, 0
    s_cselect_b32 s40, s8, s10
    s_cselect_b32 s41, s9, s11
    s_mov_b32 s42, 0x188000
    s_and_b32 s41, s41, 0xffff
    s_mov_b32 s43, 0x00020000
    s_lshr_b32 s52, s50, 1
    s_and_b32 s52, s52, 1
    s_xor_b32 s52, s52, 1
    s_and_b32 s52, s52, s57
    s_cmp_eq_u32 s52, 1
    s_cselect_b32 s44, s8, s10
    s_cselect_b32 s45, s9, s11
    s_mov_b32 s46, 0x188000
    s_and_b32 s45, s45, 0xffff
    s_mov_b32 s47, 0x00020000
    v_and_b32 v24, 15, v1
    v_lshrrev_b32 v25, 1, v24
    v_lshrrev_b32 v26, 4, v1
    v_xor_b32 v25, v25, v26
    s_lshl_b32 s52, s51, 6
    v_add_u32 v24, s52, v24
    v_lshlrev_b32 v24, 7, v24
    v_lshl_add_u32 v24, v25, 4, v24
    v_add_u32 v9, 81920, v24
    v_xor_b32 v10, 64, v9
    s_cmp_ge_u32 s50, 4
    s_cbranch_scc1 K1_DMAW
    s_cmp_eq_u32 s57, 0
    s_cbranch_scc1 K1_QKV6
K1_FFN6:
    s_and_b32 s52, s50, 2
    s_add_u32 s53, s52, 0
    v_lshrrev_b32 v24, 4, v1
    v_lshrrev_b32 v25, 2, v1
    v_and_b32 v25, 3, v25
    v_and_b32 v26, 3, v1
    v_lshlrev_b32 v12, 3, v26
    v_and_b32 v26, 1, v24
    v_lshl_add_u32 v12, v24, 10, v12
    v_lshl_add_u32 v12, v25, 7, v12
    v_lshrrev_b32 v27, 1, v25
    v_lshl_or_b32 v27, v26, 1, v27
    v_xor_b32 v27, s53, v27
    v_lshl_add_u32 v12, v27, 5, v12
    v_add_u32 v13, 8192, v12
    s_add_u32 s53, s52, 1
    v_lshrrev_b32 v24, 4, v1
    v_lshrrev_b32 v25, 2, v1
    v_and_b32 v25, 3, v25
    v_and_b32 v26, 3, v1
    v_lshlrev_b32 v14, 3, v26
    v_and_b32 v26, 1, v24
    v_lshl_add_u32 v14, v24, 10, v14
    v_lshl_add_u32 v14, v25, 7, v14
    v_lshrrev_b32 v27, 1, v25
    v_lshl_or_b32 v27, v26, 1, v27
    v_xor_b32 v27, s53, v27
    v_lshl_add_u32 v14, v27, 5, v14
    v_add_u32 v15, 8192, v14
    s_lshr_b32 s53, s50, 1
    v_lshrrev_b32 v24, 4, v1
    v_lshrrev_b32 v25, 2, v1
    v_and_b32 v25, 3, v25
    v_and_b32 v26, 3, v1
    v_lshlrev_b32 v16, 3, v26
    v_and_b32 v26, 1, v24
    v_lshrrev_b32 v27, 1, v24
    v_lshl_add_u32 v16, v27, 10, v16
    v_lshl_add_u32 v16, v26, 9, v16
    v_lshl_add_u32 v16, v25, 6, v16
    v_xor_b32 v27, s53, v26
    v_lshl_add_u32 v16, v27, 5, v16
    v_add_u32 v16, 16384, v16
    v_add_u32 v17, 2048, v16
    v_add_u32 v18, 40960, v12
    v_add_u32 v19, 40960, v13
    v_add_u32 v20, 40960, v14
    v_add_u32 v21, 40960, v15
    v_add_u32 v22, 40960, v16
    v_add_u32 v23, 40960, v17
    s_cmp_eq_u32 s50, 0
    s_cselect_b32 s53, s4, s6
    s_cselect_b32 s54, s5, s7
    s_cmp_eq_u32 s50, 2
    s_cselect_b32 s53, s8, s53
    s_cselect_b32 s54, s9, s54
    s_cmp_eq_u32 s50, 3
    s_cselect_b32 s53, s10, s53
    s_cselect_b32 s54, s11, s54
    s_mov_b32 s28, s53
    s_and_b32 s29, s54, 0xffff
    s_mov_b32 s55, 1204224
    s_cmp_eq_u32 s50, 1
    s_cselect_b32 s30, s55, 1605632
    s_mov_b32 s55, 1835008
    s_cmp_eq_u32 s50, 0
    s_cselect_b32 s30, s55, s30
    s_mov_b32 s31, 0x00020000
    s_mov_b32 s55, 7
    s_cmp_eq_u32 s50, 1
    s_cselect_b32 s55, 6, s55
    s_cmp_eq_u32 s50, 0
    s_cselect_b32 s55, 8, s55
    s_mul_i32 s52, s2, s55
    s_mul_i32 s53, s2, 21
    s_lshr_b32 s53, s53, 2
    s_cmp_eq_u32 s50, 1
    s_cselect_b32 s52, s53, s52
    s_mov_b32 s53, 128
    s_cmp_eq_u32 s50, 0
    s_cselect_b32 s53, 896, s53
    v_add_u32 v24, s52, v1
    v_mul_lo_u32 v24, v24, s53
    v_mov_b32 v25, 0x7ffffff0
    v_cmp_gt_u32 vcc, s55, v1
    s_nop 1
    v_cndmask_b32 v2, v25, v24, vcc
    s_mov_b32 s55, 229376
    s_mov_b32 s53, 172032
    s_cmp_eq_u32 s50, 1
    s_cselect_b32 s55, s53, s55
    s_cmp_eq_u32 s50, 0
    s_cselect_b32 s4, 128, s55
    s_mov_b32 s68, 0
    s_mul_i32 s52, s4, 0
    s_add_u32 s52, s52, s68
    buffer_load_dword v211, v2, s[28:31], s52 offen
    s_mul_i32 s52, s4, 1
    s_add_u32 s52, s52, s68
    buffer_load_dword v211, v2, s[28:31], s52 offen
    s_mul_i32 s52, s4, 2
    s_add_u32 s52, s52, s68
    buffer_load_dword v211, v2, s[28:31], s52 offen
    s_waitcnt vmcnt(3)
    v_mov_b32 v11, 0
    v_lshlrev_b32 v24, 16, v96
    v_and_b32 v25, s60, v96
    v_lshlrev_b32 v26, 16, v100
    v_and_b32 v27, s60, v100
    v_pk_mul_f32 v[24:25], v[24:25], v[26:27]
    v_cvt_pk_bf16_f32 v28, v24, v25
    v_lshlrev_b32 v24, 16, v28
    v_and_b32 v25, s60, v28
    v_add_f32 v11, v11, v24
    v_add_f32 v11, v11, v25
    v_lshlrev_b32 v24, 16, v97
    v_and_b32 v25, s60, v97
    v_lshlrev_b32 v26, 16, v101
    v_and_b32 v27, s60, v101
    v_pk_mul_f32 v[24:25], v[24:25], v[26:27]
    v_cvt_pk_bf16_f32 v28, v24, v25
    v_lshlrev_b32 v24, 16, v28
    v_and_b32 v25, s60, v28
    v_add_f32 v11, v11, v24
    v_add_f32 v11, v11, v25
    v_lshlrev_b32 v24, 16, v98
    v_and_b32 v25, s60, v98
    v_lshlrev_b32 v26, 16, v102
    v_and_b32 v27, s60, v102
    v_pk_mul_f32 v[24:25], v[24:25], v[26:27]
    v_cvt_pk_bf16_f32 v28, v24, v25
    v_lshlrev_b32 v24, 16, v28
    v_and_b32 v25, s60, v28
    v_add_f32 v11, v11, v24
    v_add_f32 v11, v11, v25
    v_lshlrev_b32 v24, 16, v99
    v_and_b32 v25, s60, v99
    v_lshlrev_b32 v26, 16, v103
    v_and_b32 v27, s60, v103
    v_pk_mul_f32 v[24:25], v[24:25], v[26:27]
    v_cvt_pk_bf16_f32 v28, v24, v25
    v_lshlrev_b32 v24, 16, v28
    v_and_b32 v25, s60, v28
    v_add_f32 v11, v11, v24
    v_add_f32 v11, v11, v25
    s_nop 1
    v_add_f32_dpp v11, v11, v11 quad_perm:[1,0,3,2] row_mask:0xf bank_mask:0xf
    s_nop 1
    v_add_f32_dpp v11, v11, v11 quad_perm:[2,3,0,1] row_mask:0xf bank_mask:0xf
    s_nop 1
    v_add_f32_dpp v11, v11, v11 row_half_mirror row_mask:0xf bank_mask:0xf
    s_nop 1
    v_add_f32_dpp v11, v11, v11 row_mirror row_mask:0xf bank_mask:0xf
    s_nop 1
    v_readlane_b32 s52, v11, 16
    v_readlane_b32 s53, v11, 32
    v_readlane_b32 s54, v11, 48
    s_nop 1
    v_add_f32 v11, s52, v11
    v_add_f32 v11, s53, v11
    v_add_f32 v11, s54, v11
    v_cvt_pk_bf16_f32 v11, v11, v11
    v_lshlrev_b32 v11, 16, v11
    v_mul_f32 v11, s62, v11
    v_exp_f32 v11, v11
    s_nop 0
    v_add_f32 v11, 1.0, v11
    v_rcp_f32 v11, v11
    s_nop 0
    v_cvt_pk_bf16_f32 v11, v11, v11
    v_lshlrev_b32 v11, 16, v11
    s_barrier
    ds_read_b128 v[32:35], v9 offset:0
    ds_read_b128 v[36:39], v9 offset:2048
    ds_read_b128 v[40:43], v9 offset:4096
    ds_read_b128 v[44:47], v9 offset:6144
    ds_read_b64_tr_b16 v[64:65], v12 offset:0
    ds_read_b64_tr_b16 v[66:67], v12 offset:512
    ds_read_b64_tr_b16 v[68:69], v13 offset:0
    ds_read_b64_tr_b16 v[70:71], v13 offset:512
    ds_read_b64_tr_b16 v[72:73], v14 offset:0
    ds_read_b64_tr_b16 v[74:75], v14 offset:512
    ds_read_b64_tr_b16 v[76:77], v15 offset:0
    ds_read_b64_tr_b16 v[78:79], v15 offset:512
    ds_read_b64_tr_b16 v[80:81], v16 offset:0
    ds_read_b64_tr_b16 v[82:83], v16 offset:256
    ds_read_b64_tr_b16 v[84:85], v17 offset:0
    ds_read_b64_tr_b16 v[86:87], v17 offset:256
    s_waitcnt lgkmcnt(0)
    s_barrier
    s_mul_i32 s52, s4, 3
    s_add_u32 s52, s52, s68
    buffer_load_dword v211, v2, s[28:31], s52 offen
    v_mfma_f32_16x16x32_bf16 v[112:115], v[64:67], v[32:35], 0
    ds_read_b128 v[48:51], v10 offset:0
    v_mfma_f32_16x16x32_bf16 v[116:119], v[64:67], v[36:39], 0
    ds_read_b128 v[52:55], v10 offset:2048
    v_mfma_f32_16x16x32_bf16 v[120:123], v[64:67], v[40:43], 0
    ds_read_b128 v[56:59], v10 offset:4096
    v_mfma_f32_16x16x32_bf16 v[124:127], v[64:67], v[44:47], 0
    ds_read_b128 v[60:63], v10 offset:6144
    v_mfma_f32_16x16x32_bf16 v[128:131], v[68:71], v[32:35], 0
    ds_read_b64_tr_b16 v[88:89], v12 offset:20480
    v_mfma_f32_16x16x32_bf16 v[132:135], v[68:71], v[36:39], 0
    ds_read_b64_tr_b16 v[90:91], v12 offset:20992
    v_mfma_f32_16x16x32_bf16 v[136:139], v[68:71], v[40:43], 0
    ds_read_b64_tr_b16 v[92:93], v13 offset:20480
    v_mfma_f32_16x16x32_bf16 v[140:143], v[68:71], v[44:47], 0
    ds_read_b64_tr_b16 v[94:95], v13 offset:20992
    v_mfma_f32_16x16x32_bf16 v[144:147], v[72:75], v[32:35], 0
    ds_read_b64_tr_b16 v[96:97], v14 offset:20480
    v_mfma_f32_16x16x32_bf16 v[148:151], v[72:75], v[36:39], 0
    ds_read_b64_tr_b16 v[98:99], v14 offset:20992
    v_mfma_f32_16x16x32_bf16 v[152:155], v[72:75], v[40:43], 0
    ds_read_b64_tr_b16 v[100:101], v15 offset:20480
    v_mfma_f32_16x16x32_bf16 v[156:159], v[72:75], v[44:47], 0
    ds_read_b64_tr_b16 v[102:103], v15 offset:20992
    v_mfma_f32_16x16x32_bf16 v[160:163], v[76:79], v[32:35], 0
    ds_read_b64_tr_b16 v[104:105], v16 offset:20480
    v_mfma_f32_16x16x32_bf16 v[164:167], v[76:79], v[36:39], 0
    ds_read_b64_tr_b16 v[106:107], v16 offset:20736
    v_mfma_f32_16x16x32_bf16 v[168:171], v[76:79], v[40:43], 0
    ds_read_b64_tr_b16 v[108:109], v17 offset:20480
    v_mfma_f32_16x16x32_bf16 v[172:175], v[76:79], v[44:47], 0
    ds_read_b64_tr_b16 v[110:111], v17 offset:20736
    v_mfma_f32_16x16x32_bf16 v[176:179], v[80:83], v[32:35], 0
    v_mfma_f32_16x16x32_bf16 v[180:183], v[80:83], v[36:39], 0
    v_mfma_f32_16x16x32_bf16 v[184:187], v[80:83], v[40:43], 0
    v_mfma_f32_16x16x32_bf16 v[188:191], v[80:83], v[44:47], 0
    v_mfma_f32_16x16x32_bf16 v[192:195], v[84:87], v[32:35], 0
    v_mfma_f32_16x16x32_bf16 v[196:199], v[84:87], v[36:39], 0
    v_mfma_f32_16x16x32_bf16 v[200:203], v[84:87], v[40:43], 0
    v_mfma_f32_16x16x32_bf16 v[204:207], v[84:87], v[44:47], 0
    s_waitcnt lgkmcnt(0)
    s_barrier
    s_mul_i32 s52, s4, 4
    s_add_u32 s52, s52, s68
    buffer_load_dword v211, v2, s[28:31], s52 offen
    v_mfma_f32_16x16x32_bf16 v[112:115], v[88:91], v[48:51], v[112:115]
    ds_read_b128 v[32:35], v9 offset:16384
    v_mfma_f32_16x16x32_bf16 v[116:119], v[88:91], v[52:55], v[116:119]
    ds_read_b128 v[36:39], v9 offset:18432
    v_mfma_f32_16x16x32_bf16 v[120:123], v[88:91], v[56:59], v[120:123]
    ds_read_b128 v[40:43], v9 offset:20480
    v_mfma_f32_16x16x32_bf16 v[124:127], v[88:91], v[60:63], v[124:127]
    ds_read_b128 v[44:47], v9 offset:22528
    v_mfma_f32_16x16x32_bf16 v[128:131], v[92:95], v[48:51], v[128:131]
    ds_read_b64_tr_b16 v[64:65], v18 offset:0
    v_mfma_f32_16x16x32_bf16 v[132:135], v[92:95], v[52:55], v[132:135]
    ds_read_b64_tr_b16 v[66:67], v18 offset:512
    v_mfma_f32_16x16x32_bf16 v[136:139], v[92:95], v[56:59], v[136:139]
    ds_read_b64_tr_b16 v[68:69], v19 offset:0
    v_mfma_f32_16x16x32_bf16 v[140:143], v[92:95], v[60:63], v[140:143]
    ds_read_b64_tr_b16 v[70:71], v19 offset:512
    v_mfma_f32_16x16x32_bf16 v[144:147], v[96:99], v[48:51], v[144:147]
    ds_read_b64_tr_b16 v[72:73], v20 offset:0
    v_mfma_f32_16x16x32_bf16 v[148:151], v[96:99], v[52:55], v[148:151]
    ds_read_b64_tr_b16 v[74:75], v20 offset:512
    v_mfma_f32_16x16x32_bf16 v[152:155], v[96:99], v[56:59], v[152:155]
    ds_read_b64_tr_b16 v[76:77], v21 offset:0
    v_mfma_f32_16x16x32_bf16 v[156:159], v[96:99], v[60:63], v[156:159]
    ds_read_b64_tr_b16 v[78:79], v21 offset:512
    v_mfma_f32_16x16x32_bf16 v[160:163], v[100:103], v[48:51], v[160:163]
    ds_read_b64_tr_b16 v[80:81], v22 offset:0
    v_mfma_f32_16x16x32_bf16 v[164:167], v[100:103], v[52:55], v[164:167]
    ds_read_b64_tr_b16 v[82:83], v22 offset:256
    v_mfma_f32_16x16x32_bf16 v[168:171], v[100:103], v[56:59], v[168:171]
    ds_read_b64_tr_b16 v[84:85], v23 offset:0
    v_mfma_f32_16x16x32_bf16 v[172:175], v[100:103], v[60:63], v[172:175]
    ds_read_b64_tr_b16 v[86:87], v23 offset:256
    v_mfma_f32_16x16x32_bf16 v[176:179], v[104:107], v[48:51], v[176:179]
    v_mfma_f32_16x16x32_bf16 v[180:183], v[104:107], v[52:55], v[180:183]
    v_mfma_f32_16x16x32_bf16 v[184:187], v[104:107], v[56:59], v[184:187]
    v_mfma_f32_16x16x32_bf16 v[188:191], v[104:107], v[60:63], v[188:191]
    v_mfma_f32_16x16x32_bf16 v[192:195], v[108:111], v[48:51], v[192:195]
    v_mfma_f32_16x16x32_bf16 v[196:199], v[108:111], v[52:55], v[196:199]
    v_mfma_f32_16x16x32_bf16 v[200:203], v[108:111], v[56:59], v[200:203]
    v_mfma_f32_16x16x32_bf16 v[204:207], v[108:111], v[60:63], v[204:207]
    s_waitcnt lgkmcnt(0)
    s_barrier
    s_mul_i32 s52, s4, 5
    s_add_u32 s52, s52, s68
    buffer_load_dword v211, v2, s[28:31], s52 offen
    v_mfma_f32_16x16x32_bf16 v[112:115], v[64:67], v[32:35], v[112:115]
    ds_read_b128 v[48:51], v10 offset:16384
    v_mfma_f32_16x16x32_bf16 v[116:119], v[64:67], v[36:39], v[116:119]
    ds_read_b128 v[52:55], v10 offset:18432
    v_mfma_f32_16x16x32_bf16 v[120:123], v[64:67], v[40:43], v[120:123]
    ds_read_b128 v[56:59], v10 offset:20480
    v_mfma_f32_16x16x32_bf16 v[124:127], v[64:67], v[44:47], v[124:127]
    ds_read_b128 v[60:63], v10 offset:22528
    v_mfma_f32_16x16x32_bf16 v[128:131], v[68:71], v[32:35], v[128:131]
    ds_read_b64_tr_b16 v[88:89], v18 offset:20480
    v_mfma_f32_16x16x32_bf16 v[132:135], v[68:71], v[36:39], v[132:135]
    ds_read_b64_tr_b16 v[90:91], v18 offset:20992
    v_mfma_f32_16x16x32_bf16 v[136:139], v[68:71], v[40:43], v[136:139]
    ds_read_b64_tr_b16 v[92:93], v19 offset:20480
    v_mfma_f32_16x16x32_bf16 v[140:143], v[68:71], v[44:47], v[140:143]
    ds_read_b64_tr_b16 v[94:95], v19 offset:20992
    v_mfma_f32_16x16x32_bf16 v[144:147], v[72:75], v[32:35], v[144:147]
    ds_read_b64_tr_b16 v[96:97], v20 offset:20480
    v_mfma_f32_16x16x32_bf16 v[148:151], v[72:75], v[36:39], v[148:151]
    ds_read_b64_tr_b16 v[98:99], v20 offset:20992
    v_mfma_f32_16x16x32_bf16 v[152:155], v[72:75], v[40:43], v[152:155]
    ds_read_b64_tr_b16 v[100:101], v21 offset:20480
    v_mfma_f32_16x16x32_bf16 v[156:159], v[72:75], v[44:47], v[156:159]
    ds_read_b64_tr_b16 v[102:103], v21 offset:20992
    v_mfma_f32_16x16x32_bf16 v[160:163], v[76:79], v[32:35], v[160:163]
    ds_read_b64_tr_b16 v[104:105], v22 offset:20480
    v_mfma_f32_16x16x32_bf16 v[164:167], v[76:79], v[36:39], v[164:167]
    ds_read_b64_tr_b16 v[106:107], v22 offset:20736
    v_mfma_f32_16x16x32_bf16 v[168:171], v[76:79], v[40:43], v[168:171]
    ds_read_b64_tr_b16 v[108:109], v23 offset:20480
    v_mfma_f32_16x16x32_bf16 v[172:175], v[76:79], v[44:47], v[172:175]
    ds_read_b64_tr_b16 v[110:111], v23 offset:20736
    v_mfma_f32_16x16x32_bf16 v[176:179], v[80:83], v[32:35], v[176:179]
    v_mfma_f32_16x16x32_bf16 v[180:183], v[80:83], v[36:39], v[180:183]
    v_mfma_f32_16x16x32_bf16 v[184:187], v[80:83], v[40:43], v[184:187]
    v_mfma_f32_16x16x32_bf16 v[188:191], v[80:83], v[44:47], v[188:191]
    v_mfma_f32_16x16x32_bf16 v[192:195], v[84:87], v[32:35], v[192:195]
    v_mfma_f32_16x16x32_bf16 v[196:199], v[84:87], v[36:39], v[196:199]
    v_mfma_f32_16x16x32_bf16 v[200:203], v[84:87], v[40:43], v[200:203]
    v_mfma_f32_16x16x32_bf16 v[204:207], v[84:87], v[44:47], v[204:207]
    s_waitcnt lgkmcnt(0)
    s_barrier
    s_mul_i32 s52, s4, 6
    s_add_u32 s52, s52, s68
    buffer_load_dword v211, v2, s[28:31], s52 offen
    v_mfma_f32_16x16x32_bf16 v[112:115], v[88:91], v[48:51], v[112:115]
    ds_read_b128 v[32:35], v9 offset:0
    v_mfma_f32_16x16x32_bf16 v[116:119], v[88:91], v[52:55], v[116:119]
    ds_read_b128 v[36:39], v9 offset:2048
    v_mfma_f32_16x16x32_bf16 v[120:123], v[88:91], v[56:59], v[120:123]
    ds_read_b128 v[40:43], v9 offset:4096
    v_mfma_f32_16x16x32_bf16 v[124:127], v[88:91], v[60:63], v[124:127]
    ds_read_b128 v[44:47], v9 offset:6144
    v_mfma_f32_16x16x32_bf16 v[128:131], v[92:95], v[48:51], v[128:131]
    ds_read_b64_tr_b16 v[64:65], v12 offset:0
    v_mfma_f32_16x16x32_bf16 v[132:135], v[92:95], v[52:55], v[132:135]
    ds_read_b64_tr_b16 v[66:67], v12 offset:512
    v_mfma_f32_16x16x32_bf16 v[136:139], v[92:95], v[56:59], v[136:139]
    ds_read_b64_tr_b16 v[68:69], v13 offset:0
    v_mfma_f32_16x16x32_bf16 v[140:143], v[92:95], v[60:63], v[140:143]
    ds_read_b64_tr_b16 v[70:71], v13 offset:512
    v_mfma_f32_16x16x32_bf16 v[144:147], v[96:99], v[48:51], v[144:147]
    ds_read_b64_tr_b16 v[72:73], v14 offset:0
    v_mfma_f32_16x16x32_bf16 v[148:151], v[96:99], v[52:55], v[148:151]
    ds_read_b64_tr_b16 v[74:75], v14 offset:512
    v_mfma_f32_16x16x32_bf16 v[152:155], v[96:99], v[56:59], v[152:155]
    ds_read_b64_tr_b16 v[76:77], v15 offset:0
    v_mfma_f32_16x16x32_bf16 v[156:159], v[96:99], v[60:63], v[156:159]
    ds_read_b64_tr_b16 v[78:79], v15 offset:512
    v_mfma_f32_16x16x32_bf16 v[160:163], v[100:103], v[48:51], v[160:163]
    ds_read_b64_tr_b16 v[80:81], v16 offset:0
    v_mfma_f32_16x16x32_bf16 v[164:167], v[100:103], v[52:55], v[164:167]
    ds_read_b64_tr_b16 v[82:83], v16 offset:256
    v_mfma_f32_16x16x32_bf16 v[168:171], v[100:103], v[56:59], v[168:171]
    ds_read_b64_tr_b16 v[84:85], v17 offset:0
    v_mfma_f32_16x16x32_bf16 v[172:175], v[100:103], v[60:63], v[172:175]
    ds_read_b64_tr_b16 v[86:87], v17 offset:256
    v_mfma_f32_16x16x32_bf16 v[176:179], v[104:107], v[48:51], v[176:179]
    v_mfma_f32_16x16x32_bf16 v[180:183], v[104:107], v[52:55], v[180:183]
    v_mfma_f32_16x16x32_bf16 v[184:187], v[104:107], v[56:59], v[184:187]
    v_mfma_f32_16x16x32_bf16 v[188:191], v[104:107], v[60:63], v[188:191]
    v_mfma_f32_16x16x32_bf16 v[192:195], v[108:111], v[48:51], v[192:195]
    v_mfma_f32_16x16x32_bf16 v[196:199], v[108:111], v[52:55], v[196:199]
    v_mfma_f32_16x16x32_bf16 v[200:203], v[108:111], v[56:59], v[200:203]
    v_mfma_f32_16x16x32_bf16 v[204:207], v[108:111], v[60:63], v[204:207]
    s_waitcnt lgkmcnt(0)
    s_barrier
    v_mfma_f32_16x16x32_bf16 v[112:115], v[64:67], v[32:35], v[112:115]
    ds_read_b128 v[48:51], v10 offset:0
    v_mfma_f32_16x16x32_bf16 v[116:119], v[64:67], v[36:39], v[116:119]
    ds_read_b128 v[52:55], v10 offset:2048
    v_mfma_f32_16x16x32_bf16 v[120:123], v[64:67], v[40:43], v[120:123]
    ds_read_b128 v[56:59], v10 offset:4096
    v_mfma_f32_16x16x32_bf16 v[124:127], v[64:67], v[44:47], v[124:127]
    ds_read_b128 v[60:63], v10 offset:6144
    v_mfma_f32_16x16x32_bf16 v[128:131], v[68:71], v[32:35], v[128:131]
    ds_read_b64_tr_b16 v[88:89], v12 offset:20480
    v_mfma_f32_16x16x32_bf16 v[132:135], v[68:71], v[36:39], v[132:135]
    ds_read_b64_tr_b16 v[90:91], v12 offset:20992
    v_mfma_f32_16x16x32_bf16 v[136:139], v[68:71], v[40:43], v[136:139]
    ds_read_b64_tr_b16 v[92:93], v13 offset:20480
    v_mfma_f32_16x16x32_bf16 v[140:143], v[68:71], v[44:47], v[140:143]
    ds_read_b64_tr_b16 v[94:95], v13 offset:20992
    v_mfma_f32_16x16x32_bf16 v[144:147], v[72:75], v[32:35], v[144:147]
    ds_read_b64_tr_b16 v[96:97], v14 offset:20480
    v_mfma_f32_16x16x32_bf16 v[148:151], v[72:75], v[36:39], v[148:151]
    ds_read_b64_tr_b16 v[98:99], v14 offset:20992
    v_mfma_f32_16x16x32_bf16 v[152:155], v[72:75], v[40:43], v[152:155]
    ds_read_b64_tr_b16 v[100:101], v15 offset:20480
    v_mfma_f32_16x16x32_bf16 v[156:159], v[72:75], v[44:47], v[156:159]
    ds_read_b64_tr_b16 v[102:103], v15 offset:20992
    v_mfma_f32_16x16x32_bf16 v[160:163], v[76:79], v[32:35], v[160:163]
    ds_read_b64_tr_b16 v[104:105], v16 offset:20480
    v_mfma_f32_16x16x32_bf16 v[164:167], v[76:79], v[36:39], v[164:167]
    ds_read_b64_tr_b16 v[106:107], v16 offset:20736
    v_mfma_f32_16x16x32_bf16 v[168:171], v[76:79], v[40:43], v[168:171]
    ds_read_b64_tr_b16 v[108:109], v17 offset:20480
    v_mfma_f32_16x16x32_bf16 v[172:175], v[76:79], v[44:47], v[172:175]
    ds_read_b64_tr_b16 v[110:111], v17 offset:20736
    v_mfma_f32_16x16x32_bf16 v[176:179], v[80:83], v[32:35], v[176:179]
    v_mfma_f32_16x16x32_bf16 v[180:183], v[80:83], v[36:39], v[180:183]
    v_mfma_f32_16x16x32_bf16 v[184:187], v[80:83], v[40:43], v[184:187]
    v_mfma_f32_16x16x32_bf16 v[188:191], v[80:83], v[44:47], v[188:191]
    v_mfma_f32_16x16x32_bf16 v[192:195], v[84:87], v[32:35], v[192:195]
    v_mfma_f32_16x16x32_bf16 v[196:199], v[84:87], v[36:39], v[196:199]
    v_mfma_f32_16x16x32_bf16 v[200:203], v[84:87], v[40:43], v[200:203]
    v_mfma_f32_16x16x32_bf16 v[204:207], v[84:87], v[44:47], v[204:207]
    s_waitcnt lgkmcnt(0)
    s_barrier
    v_mfma_f32_16x16x32_bf16 v[112:115], v[88:91], v[48:51], v[112:115]
    ds_read_b128 v[32:35], v9 offset:16384
    v_mfma_f32_16x16x32_bf16 v[116:119], v[88:91], v[52:55], v[116:119]
    ds_read_b128 v[36:39], v9 offset:18432
    v_mfma_f32_16x16x32_bf16 v[120:123], v[88:91], v[56:59], v[120:123]
    ds_read_b128 v[40:43], v9 offset:20480
    v_mfma_f32_16x16x32_bf16 v[124:127], v[88:91], v[60:63], v[124:127]
    ds_read_b128 v[44:47], v9 offset:22528
    v_mfma_f32_16x16x32_bf16 v[128:131], v[92:95], v[48:51], v[128:131]
    ds_read_b64_tr_b16 v[64:65], v18 offset:0
    v_mfma_f32_16x16x32_bf16 v[132:135], v[92:95], v[52:55], v[132:135]
    ds_read_b64_tr_b16 v[66:67], v18 offset:512
    v_mfma_f32_16x16x32_bf16 v[136:139], v[92:95], v[56:59], v[136:139]
    ds_read_b64_tr_b16 v[68:69], v19 offset:0
    v_mfma_f32_16x16x32_bf16 v[140:143], v[92:95], v[60:63], v[140:143]
    ds_read_b64_tr_b16 v[70:71], v19 offset:512
    v_mfma_f32_16x16x32_bf16 v[144:147], v[96:99], v[48:51], v[144:147]
    ds_read_b64_tr_b16 v[72:73], v20 offset:0
    v_mfma_f32_16x16x32_bf16 v[148:151], v[96:99], v[52:55], v[148:151]
    ds_read_b64_tr_b16 v[74:75], v20 offset:512
    v_mfma_f32_16x16x32_bf16 v[152:155], v[96:99], v[56:59], v[152:155]
    ds_read_b64_tr_b16 v[76:77], v21 offset:0
    v_mfma_f32_16x16x32_bf16 v[156:159], v[96:99], v[60:63], v[156:159]
    ds_read_b64_tr_b16 v[78:79], v21 offset:512
    v_mfma_f32_16x16x32_bf16 v[160:163], v[100:103], v[48:51], v[160:163]
    ds_read_b64_tr_b16 v[80:81], v22 offset:0
    v_mfma_f32_16x16x32_bf16 v[164:167], v[100:103], v[52:55], v[164:167]
    ds_read_b64_tr_b16 v[82:83], v22 offset:256
    v_mfma_f32_16x16x32_bf16 v[168:171], v[100:103], v[56:59], v[168:171]
    ds_read_b64_tr_b16 v[84:85], v23 offset:0
    v_mfma_f32_16x16x32_bf16 v[172:175], v[100:103], v[60:63], v[172:175]
    ds_read_b64_tr_b16 v[86:87], v23 offset:256
    v_mfma_f32_16x16x32_bf16 v[176:179], v[104:107], v[48:51], v[176:179]
    v_mfma_f32_16x16x32_bf16 v[180:183], v[104:107], v[52:55], v[180:183]
    v_mfma_f32_16x16x32_bf16 v[184:187], v[104:107], v[56:59], v[184:187]
    v_mfma_f32_16x16x32_bf16 v[188:191], v[104:107], v[60:63], v[188:191]
    v_mfma_f32_16x16x32_bf16 v[192:195], v[108:111], v[48:51], v[192:195]
    v_mfma_f32_16x16x32_bf16 v[196:199], v[108:111], v[52:55], v[196:199]
    v_mfma_f32_16x16x32_bf16 v[200:203], v[108:111], v[56:59], v[200:203]
    v_mfma_f32_16x16x32_bf16 v[204:207], v[108:111], v[60:63], v[204:207]
    s_waitcnt lgkmcnt(0)
    s_barrier
    v_mfma_f32_16x16x32_bf16 v[112:115], v[64:67], v[32:35], v[112:115]
    ds_read_b128 v[48:51], v10 offset:16384
    v_mfma_f32_16x16x32_bf16 v[116:119], v[64:67], v[36:39], v[116:119]
    ds_read_b128 v[52:55], v10 offset:18432
    v_mfma_f32_16x16x32_bf16 v[120:123], v[64:67], v[40:43], v[120:123]
    ds_read_b128 v[56:59], v10 offset:20480
    v_mfma_f32_16x16x32_bf16 v[124:127], v[64:67], v[44:47], v[124:127]
    ds_read_b128 v[60:63], v10 offset:22528
    v_mfma_f32_16x16x32_bf16 v[128:131], v[68:71], v[32:35], v[128:131]
    ds_read_b64_tr_b16 v[88:89], v18 offset:20480
    v_mfma_f32_16x16x32_bf16 v[132:135], v[68:71], v[36:39], v[132:135]
    ds_read_b64_tr_b16 v[90:91], v18 offset:20992
    v_mfma_f32_16x16x32_bf16 v[136:139], v[68:71], v[40:43], v[136:139]
    ds_read_b64_tr_b16 v[92:93], v19 offset:20480
    v_mfma_f32_16x16x32_bf16 v[140:143], v[68:71], v[44:47], v[140:143]
    ds_read_b64_tr_b16 v[94:95], v19 offset:20992
    v_mfma_f32_16x16x32_bf16 v[144:147], v[72:75], v[32:35], v[144:147]
    ds_read_b64_tr_b16 v[96:97], v20 offset:20480
    v_mfma_f32_16x16x32_bf16 v[148:151], v[72:75], v[36:39], v[148:151]
    ds_read_b64_tr_b16 v[98:99], v20 offset:20992
    v_mfma_f32_16x16x32_bf16 v[152:155], v[72:75], v[40:43], v[152:155]
    ds_read_b64_tr_b16 v[100:101], v21 offset:20480
    v_mfma_f32_16x16x32_bf16 v[156:159], v[72:75], v[44:47], v[156:159]
    ds_read_b64_tr_b16 v[102:103], v21 offset:20992
    v_mfma_f32_16x16x32_bf16 v[160:163], v[76:79], v[32:35], v[160:163]
    ds_read_b64_tr_b16 v[104:105], v22 offset:20480
    v_mfma_f32_16x16x32_bf16 v[164:167], v[76:79], v[36:39], v[164:167]
    ds_read_b64_tr_b16 v[106:107], v22 offset:20736
    v_mfma_f32_16x16x32_bf16 v[168:171], v[76:79], v[40:43], v[168:171]
    ds_read_b64_tr_b16 v[108:109], v23 offset:20480
    v_mfma_f32_16x16x32_bf16 v[172:175], v[76:79], v[44:47], v[172:175]
    ds_read_b64_tr_b16 v[110:111], v23 offset:20736
    v_mfma_f32_16x16x32_bf16 v[176:179], v[80:83], v[32:35], v[176:179]
    v_mfma_f32_16x16x32_bf16 v[180:183], v[80:83], v[36:39], v[180:183]
    v_mfma_f32_16x16x32_bf16 v[184:187], v[80:83], v[40:43], v[184:187]
    v_mfma_f32_16x16x32_bf16 v[188:191], v[80:83], v[44:47], v[188:191]
    v_mfma_f32_16x16x32_bf16 v[192:195], v[84:87], v[32:35], v[192:195]
    v_mfma_f32_16x16x32_bf16 v[196:199], v[84:87], v[36:39], v[196:199]
    v_mfma_f32_16x16x32_bf16 v[200:203], v[84:87], v[40:43], v[200:203]
    v_mfma_f32_16x16x32_bf16 v[204:207], v[84:87], v[44:47], v[204:207]
    s_waitcnt lgkmcnt(0)
    s_barrier
    v_mfma_f32_16x16x32_bf16 v[112:115], v[88:91], v[48:51], v[112:115]
    ds_read_b128 v[32:35], v9 offset:0
    v_mfma_f32_16x16x32_bf16 v[116:119], v[88:91], v[52:55], v[116:119]
    ds_read_b128 v[36:39], v9 offset:2048
    v_mfma_f32_16x16x32_bf16 v[120:123], v[88:91], v[56:59], v[120:123]
    ds_read_b128 v[40:43], v9 offset:4096
    v_mfma_f32_16x16x32_bf16 v[124:127], v[88:91], v[60:63], v[124:127]
    ds_read_b128 v[44:47], v9 offset:6144
    v_mfma_f32_16x16x32_bf16 v[128:131], v[92:95], v[48:51], v[128:131]
    ds_read_b64_tr_b16 v[64:65], v12 offset:0
    v_mfma_f32_16x16x32_bf16 v[132:135], v[92:95], v[52:55], v[132:135]
    ds_read_b64_tr_b16 v[66:67], v12 offset:512
    v_mfma_f32_16x16x32_bf16 v[136:139], v[92:95], v[56:59], v[136:139]
    ds_read_b64_tr_b16 v[68:69], v13 offset:0
    v_mfma_f32_16x16x32_bf16 v[140:143], v[92:95], v[60:63], v[140:143]
    ds_read_b64_tr_b16 v[70:71], v13 offset:512
    v_mfma_f32_16x16x32_bf16 v[144:147], v[96:99], v[48:51], v[144:147]
    ds_read_b64_tr_b16 v[72:73], v14 offset:0
    v_mfma_f32_16x16x32_bf16 v[148:151], v[96:99], v[52:55], v[148:151]
    ds_read_b64_tr_b16 v[74:75], v14 offset:512
    v_mfma_f32_16x16x32_bf16 v[152:155], v[96:99], v[56:59], v[152:155]
    ds_read_b64_tr_b16 v[76:77], v15 offset:0
    v_mfma_f32_16x16x32_bf16 v[156:159], v[96:99], v[60:63], v[156:159]
    ds_read_b64_tr_b16 v[78:79], v15 offset:512
    v_mfma_f32_16x16x32_bf16 v[160:163], v[100:103], v[48:51], v[160:163]
    ds_read_b64_tr_b16 v[80:81], v16 offset:0
    v_mfma_f32_16x16x32_bf16 v[164:167], v[100:103], v[52:55], v[164:167]
    ds_read_b64_tr_b16 v[82:83], v16 offset:256
    v_mfma_f32_16x16x32_bf16 v[168:171], v[100:103], v[56:59], v[168:171]
    ds_read_b64_tr_b16 v[84:85], v17 offset:0
    v_mfma_f32_16x16x32_bf16 v[172:175], v[100:103], v[60:63], v[172:175]
    ds_read_b64_tr_b16 v[86:87], v17 offset:256
    v_mfma_f32_16x16x32_bf16 v[176:179], v[104:107], v[48:51], v[176:179]
    v_mfma_f32_16x16x32_bf16 v[180:183], v[104:107], v[52:55], v[180:183]
    v_mfma_f32_16x16x32_bf16 v[184:187], v[104:107], v[56:59], v[184:187]
    v_mfma_f32_16x16x32_bf16 v[188:191], v[104:107], v[60:63], v[188:191]
    v_mfma_f32_16x16x32_bf16 v[192:195], v[108:111], v[48:51], v[192:195]
    v_mfma_f32_16x16x32_bf16 v[196:199], v[108:111], v[52:55], v[196:199]
    v_mfma_f32_16x16x32_bf16 v[200:203], v[108:111], v[56:59], v[200:203]
    v_mfma_f32_16x16x32_bf16 v[204:207], v[108:111], v[60:63], v[204:207]
    s_waitcnt lgkmcnt(0)
    s_barrier
    v_mfma_f32_16x16x32_bf16 v[112:115], v[64:67], v[32:35], v[112:115]
    ds_read_b128 v[48:51], v10 offset:0
    v_mfma_f32_16x16x32_bf16 v[116:119], v[64:67], v[36:39], v[116:119]
    ds_read_b128 v[52:55], v10 offset:2048
    v_mfma_f32_16x16x32_bf16 v[120:123], v[64:67], v[40:43], v[120:123]
    ds_read_b128 v[56:59], v10 offset:4096
    v_mfma_f32_16x16x32_bf16 v[124:127], v[64:67], v[44:47], v[124:127]
    ds_read_b128 v[60:63], v10 offset:6144
    v_mfma_f32_16x16x32_bf16 v[128:131], v[68:71], v[32:35], v[128:131]
    ds_read_b64_tr_b16 v[88:89], v12 offset:20480
    v_mfma_f32_16x16x32_bf16 v[132:135], v[68:71], v[36:39], v[132:135]
    ds_read_b64_tr_b16 v[90:91], v12 offset:20992
    v_mfma_f32_16x16x32_bf16 v[136:139], v[68:71], v[40:43], v[136:139]
    ds_read_b64_tr_b16 v[92:93], v13 offset:20480
    v_mfma_f32_16x16x32_bf16 v[140:143], v[68:71], v[44:47], v[140:143]
    ds_read_b64_tr_b16 v[94:95], v13 offset:20992
    v_mfma_f32_16x16x32_bf16 v[144:147], v[72:75], v[32:35], v[144:147]
    ds_read_b64_tr_b16 v[96:97], v14 offset:20480
    v_mfma_f32_16x16x32_bf16 v[148:151], v[72:75], v[36:39], v[148:151]
    ds_read_b64_tr_b16 v[98:99], v14 offset:20992
    v_mfma_f32_16x16x32_bf16 v[152:155], v[72:75], v[40:43], v[152:155]
    ds_read_b64_tr_b16 v[100:101], v15 offset:20480
    v_mfma_f32_16x16x32_bf16 v[156:159], v[72:75], v[44:47], v[156:159]
    ds_read_b64_tr_b16 v[102:103], v15 offset:20992
    v_mfma_f32_16x16x32_bf16 v[160:163], v[76:79], v[32:35], v[160:163]
    ds_read_b64_tr_b16 v[104:105], v16 offset:20480
    v_mfma_f32_16x16x32_bf16 v[164:167], v[76:79], v[36:39], v[164:167]
    ds_read_b64_tr_b16 v[106:107], v16 offset:20736
    v_mfma_f32_16x16x32_bf16 v[168:171], v[76:79], v[40:43], v[168:171]
    ds_read_b64_tr_b16 v[108:109], v17 offset:20480
    v_mfma_f32_16x16x32_bf16 v[172:175], v[76:79], v[44:47], v[172:175]
    ds_read_b64_tr_b16 v[110:111], v17 offset:20736
    v_mfma_f32_16x16x32_bf16 v[176:179], v[80:83], v[32:35], v[176:179]
    v_mfma_f32_16x16x32_bf16 v[180:183], v[80:83], v[36:39], v[180:183]
    v_mfma_f32_16x16x32_bf16 v[184:187], v[80:83], v[40:43], v[184:187]
    v_mfma_f32_16x16x32_bf16 v[188:191], v[80:83], v[44:47], v[188:191]
    v_mfma_f32_16x16x32_bf16 v[192:195], v[84:87], v[32:35], v[192:195]
    v_mfma_f32_16x16x32_bf16 v[196:199], v[84:87], v[36:39], v[196:199]
    v_mfma_f32_16x16x32_bf16 v[200:203], v[84:87], v[40:43], v[200:203]
    v_mfma_f32_16x16x32_bf16 v[204:207], v[84:87], v[44:47], v[204:207]
    s_waitcnt lgkmcnt(0)
    s_barrier
    v_mfma_f32_16x16x32_bf16 v[112:115], v[88:91], v[48:51], v[112:115]
    ds_read_b128 v[32:35], v9 offset:16384
    v_mfma_f32_16x16x32_bf16 v[116:119], v[88:91], v[52:55], v[116:119]
    ds_read_b128 v[36:39], v9 offset:18432
    v_mfma_f32_16x16x32_bf16 v[120:123], v[88:91], v[56:59], v[120:123]
    ds_read_b128 v[40:43], v9 offset:20480
    v_mfma_f32_16x16x32_bf16 v[124:127], v[88:91], v[60:63], v[124:127]
    ds_read_b128 v[44:47], v9 offset:22528
    v_mfma_f32_16x16x32_bf16 v[128:131], v[92:95], v[48:51], v[128:131]
    ds_read_b64_tr_b16 v[64:65], v18 offset:0
    v_mfma_f32_16x16x32_bf16 v[132:135], v[92:95], v[52:55], v[132:135]
    ds_read_b64_tr_b16 v[66:67], v18 offset:512
    v_mfma_f32_16x16x32_bf16 v[136:139], v[92:95], v[56:59], v[136:139]
    ds_read_b64_tr_b16 v[68:69], v19 offset:0
    v_mfma_f32_16x16x32_bf16 v[140:143], v[92:95], v[60:63], v[140:143]
    ds_read_b64_tr_b16 v[70:71], v19 offset:512
    v_mfma_f32_16x16x32_bf16 v[144:147], v[96:99], v[48:51], v[144:147]
    ds_read_b64_tr_b16 v[72:73], v20 offset:0
    v_mfma_f32_16x16x32_bf16 v[148:151], v[96:99], v[52:55], v[148:151]
    ds_read_b64_tr_b16 v[74:75], v20 offset:512
    v_mfma_f32_16x16x32_bf16 v[152:155], v[96:99], v[56:59], v[152:155]
    ds_read_b64_tr_b16 v[76:77], v21 offset:0
    v_mfma_f32_16x16x32_bf16 v[156:159], v[96:99], v[60:63], v[156:159]
    ds_read_b64_tr_b16 v[78:79], v21 offset:512
    v_mfma_f32_16x16x32_bf16 v[160:163], v[100:103], v[48:51], v[160:163]
    ds_read_b64_tr_b16 v[80:81], v22 offset:0
    v_mfma_f32_16x16x32_bf16 v[164:167], v[100:103], v[52:55], v[164:167]
    ds_read_b64_tr_b16 v[82:83], v22 offset:256
    v_mfma_f32_16x16x32_bf16 v[168:171], v[100:103], v[56:59], v[168:171]
    ds_read_b64_tr_b16 v[84:85], v23 offset:0
    v_mfma_f32_16x16x32_bf16 v[172:175], v[100:103], v[60:63], v[172:175]
    ds_read_b64_tr_b16 v[86:87], v23 offset:256
    v_mfma_f32_16x16x32_bf16 v[176:179], v[104:107], v[48:51], v[176:179]
    v_mfma_f32_16x16x32_bf16 v[180:183], v[104:107], v[52:55], v[180:183]
    v_mfma_f32_16x16x32_bf16 v[184:187], v[104:107], v[56:59], v[184:187]
    v_mfma_f32_16x16x32_bf16 v[188:191], v[104:107], v[60:63], v[188:191]
    v_mfma_f32_16x16x32_bf16 v[192:195], v[108:111], v[48:51], v[192:195]
    v_mfma_f32_16x16x32_bf16 v[196:199], v[108:111], v[52:55], v[196:199]
    v_mfma_f32_16x16x32_bf16 v[200:203], v[108:111], v[56:59], v[200:203]
    v_mfma_f32_16x16x32_bf16 v[204:207], v[108:111], v[60:63], v[204:207]
    s_waitcnt lgkmcnt(0)
    s_barrier
    v_mfma_f32_16x16x32_bf16 v[112:115], v[64:67], v[32:35], v[112:115]
    ds_read_b128 v[48:51], v10 offset:16384
    v_mfma_f32_16x16x32_bf16 v[116:119], v[64:67], v[36:39], v[116:119]
    ds_read_b128 v[52:55], v10 offset:18432
    v_mfma_f32_16x16x32_bf16 v[120:123], v[64:67], v[40:43], v[120:123]
    ds_read_b128 v[56:59], v10 offset:20480
    v_mfma_f32_16x16x32_bf16 v[124:127], v[64:67], v[44:47], v[124:127]
    ds_read_b128 v[60:63], v10 offset:22528
    v_mfma_f32_16x16x32_bf16 v[128:131], v[68:71], v[32:35], v[128:131]
    ds_read_b64_tr_b16 v[88:89], v18 offset:20480
    v_mfma_f32_16x16x32_bf16 v[132:135], v[68:71], v[36:39], v[132:135]
    ds_read_b64_tr_b16 v[90:91], v18 offset:20992
    v_mfma_f32_16x16x32_bf16 v[136:139], v[68:71], v[40:43], v[136:139]
    ds_read_b64_tr_b16 v[92:93], v19 offset:20480
    v_mfma_f32_16x16x32_bf16 v[140:143], v[68:71], v[44:47], v[140:143]
    ds_read_b64_tr_b16 v[94:95], v19 offset:20992
    v_mfma_f32_16x16x32_bf16 v[144:147], v[72:75], v[32:35], v[144:147]
    ds_read_b64_tr_b16 v[96:97], v20 offset:20480
    v_mfma_f32_16x16x32_bf16 v[148:151], v[72:75], v[36:39], v[148:151]
    ds_read_b64_tr_b16 v[98:99], v20 offset:20992
    v_mfma_f32_16x16x32_bf16 v[152:155], v[72:75], v[40:43], v[152:155]
    ds_read_b64_tr_b16 v[100:101], v21 offset:20480
    v_mfma_f32_16x16x32_bf16 v[156:159], v[72:75], v[44:47], v[156:159]
    ds_read_b64_tr_b16 v[102:103], v21 offset:20992
    v_mfma_f32_16x16x32_bf16 v[160:163], v[76:79], v[32:35], v[160:163]
    ds_read_b64_tr_b16 v[104:105], v22 offset:20480
    v_mfma_f32_16x16x32_bf16 v[164:167], v[76:79], v[36:39], v[164:167]
    ds_read_b64_tr_b16 v[106:107], v22 offset:20736
    v_mfma_f32_16x16x32_bf16 v[168:171], v[76:79], v[40:43], v[168:171]
    ds_read_b64_tr_b16 v[108:109], v23 offset:20480
    v_mfma_f32_16x16x32_bf16 v[172:175], v[76:79], v[44:47], v[172:175]
    ds_read_b64_tr_b16 v[110:111], v23 offset:20736
    v_mfma_f32_16x16x32_bf16 v[176:179], v[80:83], v[32:35], v[176:179]
    v_mfma_f32_16x16x32_bf16 v[180:183], v[80:83], v[36:39], v[180:183]
    v_mfma_f32_16x16x32_bf16 v[184:187], v[80:83], v[40:43], v[184:187]
    v_mfma_f32_16x16x32_bf16 v[188:191], v[80:83], v[44:47], v[188:191]
    v_mfma_f32_16x16x32_bf16 v[192:195], v[84:87], v[32:35], v[192:195]
    v_mfma_f32_16x16x32_bf16 v[196:199], v[84:87], v[36:39], v[196:199]
    v_mfma_f32_16x16x32_bf16 v[200:203], v[84:87], v[40:43], v[200:203]
    v_mfma_f32_16x16x32_bf16 v[204:207], v[84:87], v[44:47], v[204:207]
    s_waitcnt lgkmcnt(0)
    s_barrier
    s_setprio 2
    v_mfma_f32_16x16x32_bf16 v[112:115], v[88:91], v[48:51], v[112:115]
    ds_read_b128 v[32:35], v9 offset:0
    v_mfma_f32_16x16x32_bf16 v[116:119], v[88:91], v[52:55], v[116:119]
    ds_read_b128 v[36:39], v9 offset:2048
    v_mfma_f32_16x16x32_bf16 v[120:123], v[88:91], v[56:59], v[120:123]
    ds_read_b128 v[40:43], v9 offset:4096
    v_mfma_f32_16x16x32_bf16 v[124:127], v[88:91], v[60:63], v[124:127]
    ds_read_b128 v[44:47], v9 offset:6144
    v_mfma_f32_16x16x32_bf16 v[128:131], v[92:95], v[48:51], v[128:131]
    ds_read_b64_tr_b16 v[64:65], v12 offset:0
    v_mfma_f32_16x16x32_bf16 v[132:135], v[92:95], v[52:55], v[132:135]
    ds_read_b64_tr_b16 v[66:67], v12 offset:512
    v_mfma_f32_16x16x32_bf16 v[136:139], v[92:95], v[56:59], v[136:139]
    ds_read_b64_tr_b16 v[68:69], v13 offset:0
    v_mfma_f32_16x16x32_bf16 v[140:143], v[92:95], v[60:63], v[140:143]
    ds_read_b64_tr_b16 v[70:71], v13 offset:512
    v_mfma_f32_16x16x32_bf16 v[144:147], v[96:99], v[48:51], v[144:147]
    ds_read_b64_tr_b16 v[72:73], v14 offset:0
    v_mfma_f32_16x16x32_bf16 v[148:151], v[96:99], v[52:55], v[148:151]
    ds_read_b64_tr_b16 v[74:75], v14 offset:512
    v_mfma_f32_16x16x32_bf16 v[152:155], v[96:99], v[56:59], v[152:155]
    ds_read_b64_tr_b16 v[76:77], v15 offset:0
    v_mfma_f32_16x16x32_bf16 v[156:159], v[96:99], v[60:63], v[156:159]
    ds_read_b64_tr_b16 v[78:79], v15 offset:512
    v_mfma_f32_16x16x32_bf16 v[160:163], v[100:103], v[48:51], v[160:163]
    ds_read_b64_tr_b16 v[80:81], v16 offset:0
    v_mfma_f32_16x16x32_bf16 v[164:167], v[100:103], v[52:55], v[164:167]
    ds_read_b64_tr_b16 v[82:83], v16 offset:256
    v_mfma_f32_16x16x32_bf16 v[168:171], v[100:103], v[56:59], v[168:171]
    ds_read_b64_tr_b16 v[84:85], v17 offset:0
    v_mfma_f32_16x16x32_bf16 v[172:175], v[100:103], v[60:63], v[172:175]
    ds_read_b64_tr_b16 v[86:87], v17 offset:256
    v_mfma_f32_16x16x32_bf16 v[176:179], v[104:107], v[48:51], v[176:179]
    v_mfma_f32_16x16x32_bf16 v[180:183], v[104:107], v[52:55], v[180:183]
    v_mfma_f32_16x16x32_bf16 v[184:187], v[104:107], v[56:59], v[184:187]
    v_mfma_f32_16x16x32_bf16 v[188:191], v[104:107], v[60:63], v[188:191]
    v_mfma_f32_16x16x32_bf16 v[192:195], v[108:111], v[48:51], v[192:195]
    v_mfma_f32_16x16x32_bf16 v[196:199], v[108:111], v[52:55], v[196:199]
    v_mfma_f32_16x16x32_bf16 v[200:203], v[108:111], v[56:59], v[200:203]
    v_mfma_f32_16x16x32_bf16 v[204:207], v[108:111], v[60:63], v[204:207]
    s_waitcnt lgkmcnt(0)
    s_barrier
    s_mov_b32 s24, s96
    s_and_b32 s25, s97, 0xffff
    s_mov_b32 s26, 0x188000
    s_mov_b32 s27, 0x00020000
    s_lshl_b32 s52, s2, 2
    s_add_u32 s52, s52, s50
    s_mul_i32 s53, s52, 1664
    v_lshlrev_b32 v24, 7, v1
    v_mov_b32 v25, 0x7ffffff0
    v_cmp_gt_u32 vcc, 13, v1
    s_nop 1
    v_cndmask_b32 v26, v25, v24, vcc
    buffer_load_dword v208, v26, s[24:27], s53 offen
    s_mov_b32 s32, s98
    s_and_b32 s33, s99, 0xffff
    s_mov_b32 s34, 0x62000
    s_mov_b32 s35, 0x00020000
    s_mul_i32 s53, s52, 512
    v_cmp_gt_u32 vcc, 4, v1
    s_nop 1
    v_cndmask_b32 v26, v25, v24, vcc
    buffer_load_dword v210, v26, s[32:35], s53 offen
    v_mfma_f32_16x16x32_bf16 v[112:115], v[64:67], v[32:35], v[112:115]
    ds_read_b128 v[48:51], v10 offset:0
    v_mfma_f32_16x16x32_bf16 v[116:119], v[64:67], v[36:39], v[116:119]
    ds_read_b128 v[52:55], v10 offset:2048
    v_mfma_f32_16x16x32_bf16 v[120:123], v[64:67], v[40:43], v[120:123]
    ds_read_b128 v[56:59], v10 offset:4096
    v_mfma_f32_16x16x32_bf16 v[124:127], v[64:67], v[44:47], v[124:127]
    ds_read_b128 v[60:63], v10 offset:6144
    v_mfma_f32_16x16x32_bf16 v[128:131], v[68:71], v[32:35], v[128:131]
    ds_read_b64_tr_b16 v[88:89], v12 offset:20480
    v_mfma_f32_16x16x32_bf16 v[132:135], v[68:71], v[36:39], v[132:135]
    ds_read_b64_tr_b16 v[90:91], v12 offset:20992
    v_mfma_f32_16x16x32_bf16 v[136:139], v[68:71], v[40:43], v[136:139]
    ds_read_b64_tr_b16 v[92:93], v13 offset:20480
    v_mfma_f32_16x16x32_bf16 v[140:143], v[68:71], v[44:47], v[140:143]
    ds_read_b64_tr_b16 v[94:95], v13 offset:20992
    v_mfma_f32_16x16x32_bf16 v[144:147], v[72:75], v[32:35], v[144:147]
    ds_read_b64_tr_b16 v[96:97], v14 offset:20480
    v_mfma_f32_16x16x32_bf16 v[148:151], v[72:75], v[36:39], v[148:151]
    ds_read_b64_tr_b16 v[98:99], v14 offset:20992
    v_mfma_f32_16x16x32_bf16 v[152:155], v[72:75], v[40:43], v[152:155]
    ds_read_b64_tr_b16 v[100:101], v15 offset:20480
    v_mfma_f32_16x16x32_bf16 v[156:159], v[72:75], v[44:47], v[156:159]
    ds_read_b64_tr_b16 v[102:103], v15 offset:20992
    v_mfma_f32_16x16x32_bf16 v[160:163], v[76:79], v[32:35], v[160:163]
    ds_read_b64_tr_b16 v[104:105], v16 offset:20480
    v_mfma_f32_16x16x32_bf16 v[164:167], v[76:79], v[36:39], v[164:167]
    ds_read_b64_tr_b16 v[106:107], v16 offset:20736
    v_mfma_f32_16x16x32_bf16 v[168:171], v[76:79], v[40:43], v[168:171]
    ds_read_b64_tr_b16 v[108:109], v17 offset:20480
    v_mfma_f32_16x16x32_bf16 v[172:175], v[76:79], v[44:47], v[172:175]
    ds_read_b64_tr_b16 v[110:111], v17 offset:20736
    v_mfma_f32_16x16x32_bf16 v[176:179], v[80:83], v[32:35], v[176:179]
    v_mfma_f32_16x16x32_bf16 v[180:183], v[80:83], v[36:39], v[180:183]
    v_mfma_f32_16x16x32_bf16 v[184:187], v[80:83], v[40:43], v[184:187]
    v_mfma_f32_16x16x32_bf16 v[188:191], v[80:83], v[44:47], v[188:191]
    v_mfma_f32_16x16x32_bf16 v[192:195], v[84:87], v[32:35], v[192:195]
    v_mfma_f32_16x16x32_bf16 v[196:199], v[84:87], v[36:39], v[196:199]
    v_mfma_f32_16x16x32_bf16 v[200:203], v[84:87], v[40:43], v[200:203]
    v_mfma_f32_16x16x32_bf16 v[204:207], v[84:87], v[44:47], v[204:207]
    s_waitcnt lgkmcnt(0)
    v_mfma_f32_16x16x32_bf16 v[112:115], v[88:91], v[48:51], v[112:115]
    v_mfma_f32_16x16x32_bf16 v[116:119], v[88:91], v[52:55], v[116:119]
    v_mfma_f32_16x16x32_bf16 v[120:123], v[88:91], v[56:59], v[120:123]
    v_mfma_f32_16x16x32_bf16 v[124:127], v[88:91], v[60:63], v[124:127]
    v_mfma_f32_16x16x32_bf16 v[128:131], v[92:95], v[48:51], v[128:131]
    v_mfma_f32_16x16x32_bf16 v[132:135], v[92:95], v[52:55], v[132:135]
    v_mfma_f32_16x16x32_bf16 v[136:139], v[92:95], v[56:59], v[136:139]
    v_mfma_f32_16x16x32_bf16 v[140:143], v[92:95], v[60:63], v[140:143]
    v_mfma_f32_16x16x32_bf16 v[144:147], v[96:99], v[48:51], v[144:147]
    v_mfma_f32_16x16x32_bf16 v[148:151], v[96:99], v[52:55], v[148:151]
    v_mfma_f32_16x16x32_bf16 v[152:155], v[96:99], v[56:59], v[152:155]
    v_mfma_f32_16x16x32_bf16 v[156:159], v[96:99], v[60:63], v[156:159]
    v_mfma_f32_16x16x32_bf16 v[160:163], v[100:103], v[48:51], v[160:163]
    v_mfma_f32_16x16x32_bf16 v[164:167], v[100:103], v[52:55], v[164:167]
    v_mfma_f32_16x16x32_bf16 v[168:171], v[100:103], v[56:59], v[168:171]
    v_mfma_f32_16x16x32_bf16 v[172:175], v[100:103], v[60:63], v[172:175]
    v_mfma_f32_16x16x32_bf16 v[176:179], v[104:107], v[48:51], v[176:179]
    v_mfma_f32_16x16x32_bf16 v[180:183], v[104:107], v[52:55], v[180:183]
    v_mfma_f32_16x16x32_bf16 v[184:187], v[104:107], v[56:59], v[184:187]
    v_mfma_f32_16x16x32_bf16 v[188:191], v[104:107], v[60:63], v[188:191]
    v_mfma_f32_16x16x32_bf16 v[192:195], v[108:111], v[48:51], v[192:195]
    v_mfma_f32_16x16x32_bf16 v[196:199], v[108:111], v[52:55], v[196:199]
    v_mfma_f32_16x16x32_bf16 v[200:203], v[108:111], v[56:59], v[200:203]
    v_mfma_f32_16x16x32_bf16 v[204:207], v[108:111], v[60:63], v[204:207]
    s_mov_b32 s10, 0x3fb8aa3b
    s_mov_b32 s11, 0x3fb8aa3b
    s_mov_b32 s12, 0x358637bd
    s_mov_b32 s13, 0x358637bd
    s_nop 5
    v_mov_b32 v25, 0x7ffffff0
    v_mov_b32 v24, 11599872
    v_cmp_eq_u32 vcc, 0, v1
    s_nop 1
    v_cndmask_b32 v24, v25, v24, vcc
    buffer_store_dword v11, v24, s[20:23], s59 offen
    v_lshlrev_b32 v9, 4, v1
    s_mul_i32 s55, s56, 10
    s_and_b32 s52, s50, 2
    s_add_u32 s55, s55, s52
    s_add_u32 s55, s55, 32
    s_lshr_b32 s53, s55, 1
    s_lshl_b32 s53, s53, 10
    v_pk_mul_f32 v[32:33], v[112:113], s[62:63]
    v_pk_mul_f32 v[34:35], v[114:115], s[62:63]
    v_exp_f32 v32, v32
    v_exp_f32 v33, v33
    v_exp_f32 v34, v34
    v_exp_f32 v35, v35
    v_pk_mul_f32 v[112:113], v[112:113], v[128:129]
    v_pk_mul_f32 v[114:115], v[114:115], v[130:131]
    v_pk_add_f32 v[32:33], v[32:33], s[64:65]
    v_pk_add_f32 v[34:35], v[34:35], s[64:65]
    v_rcp_f32 v32, v32
    v_rcp_f32 v33, v33
    v_rcp_f32 v34, v34
    v_rcp_f32 v35, v35
    s_nop 0
    v_pk_mul_f32 v[112:113], v[112:113], v[32:33]
    v_pk_mul_f32 v[114:115], v[114:115], v[34:35]
    v_cvt_pk_bf16_f32 v48, v112, v113
    v_cvt_pk_bf16_f32 v49, v114, v115
    v_pk_mul_f32 v[36:37], v[144:145], s[62:63]
    v_pk_mul_f32 v[38:39], v[146:147], s[62:63]
    v_exp_f32 v36, v36
    v_exp_f32 v37, v37
    v_exp_f32 v38, v38
    v_exp_f32 v39, v39
    v_pk_mul_f32 v[144:145], v[144:145], v[160:161]
    v_pk_mul_f32 v[146:147], v[146:147], v[162:163]
    v_pk_add_f32 v[36:37], v[36:37], s[64:65]
    v_pk_add_f32 v[38:39], v[38:39], s[64:65]
    v_rcp_f32 v36, v36
    v_rcp_f32 v37, v37
    v_rcp_f32 v38, v38
    v_rcp_f32 v39, v39
    s_nop 0
    v_pk_mul_f32 v[144:145], v[144:145], v[36:37]
    v_pk_mul_f32 v[146:147], v[146:147], v[38:39]
    v_cvt_pk_bf16_f32 v50, v144, v145
    v_cvt_pk_bf16_f32 v51, v146, v147
    s_add_u32 s52, s58, 0
    s_mul_i32 s52, s52, 57344
    s_add_u32 s52, s52, s53
    buffer_store_dwordx4 v[48:51], v9, s[20:23], s52 offen
    v_pk_mul_f32 v[32:33], v[116:117], s[62:63]
    v_pk_mul_f32 v[34:35], v[118:119], s[62:63]
    v_exp_f32 v32, v32
    v_exp_f32 v33, v33
    v_exp_f32 v34, v34
    v_exp_f32 v35, v35
    v_pk_mul_f32 v[116:117], v[116:117], v[132:133]
    v_pk_mul_f32 v[118:119], v[118:119], v[134:135]
    v_pk_add_f32 v[32:33], v[32:33], s[64:65]
    v_pk_add_f32 v[34:35], v[34:35], s[64:65]
    v_rcp_f32 v32, v32
    v_rcp_f32 v33, v33
    v_rcp_f32 v34, v34
    v_rcp_f32 v35, v35
    s_nop 0
    v_pk_mul_f32 v[116:117], v[116:117], v[32:33]
    v_pk_mul_f32 v[118:119], v[118:119], v[34:35]
    v_cvt_pk_bf16_f32 v52, v116, v117
    v_cvt_pk_bf16_f32 v53, v118, v119
    v_pk_mul_f32 v[36:37], v[148:149], s[62:63]
    v_pk_mul_f32 v[38:39], v[150:151], s[62:63]
    v_exp_f32 v36, v36
    v_exp_f32 v37, v37
    v_exp_f32 v38, v38
    v_exp_f32 v39, v39
    v_pk_mul_f32 v[148:149], v[148:149], v[164:165]
    v_pk_mul_f32 v[150:151], v[150:151], v[166:167]
    v_pk_add_f32 v[36:37], v[36:37], s[64:65]
    v_pk_add_f32 v[38:39], v[38:39], s[64:65]
    v_rcp_f32 v36, v36
    v_rcp_f32 v37, v37
    v_rcp_f32 v38, v38
    v_rcp_f32 v39, v39
    s_nop 0
    v_pk_mul_f32 v[148:149], v[148:149], v[36:37]
    v_pk_mul_f32 v[150:151], v[150:151], v[38:39]
    v_cvt_pk_bf16_f32 v54, v148, v149
    v_cvt_pk_bf16_f32 v55, v150, v151
    s_add_u32 s52, s58, 1
    s_mul_i32 s52, s52, 57344
    s_add_u32 s52, s52, s53
    buffer_store_dwordx4 v[52:55], v9, s[20:23], s52 offen
    v_pk_mul_f32 v[32:33], v[120:121], s[62:63]
    v_pk_mul_f32 v[34:35], v[122:123], s[62:63]
    v_exp_f32 v32, v32
    v_exp_f32 v33, v33
    v_exp_f32 v34, v34
    v_exp_f32 v35, v35
    v_pk_mul_f32 v[120:121], v[120:121], v[136:137]
    v_pk_mul_f32 v[122:123], v[122:123], v[138:139]
    v_pk_add_f32 v[32:33], v[32:33], s[64:65]
    v_pk_add_f32 v[34:35], v[34:35], s[64:65]
    v_rcp_f32 v32, v32
    v_rcp_f32 v33, v33
    v_rcp_f32 v34, v34
    v_rcp_f32 v35, v35
    s_nop 0
    v_pk_mul_f32 v[120:121], v[120:121], v[32:33]
    v_pk_mul_f32 v[122:123], v[122:123], v[34:35]
    v_cvt_pk_bf16_f32 v56, v120, v121
    v_cvt_pk_bf16_f32 v57, v122, v123
    v_pk_mul_f32 v[36:37], v[152:153], s[62:63]
    v_pk_mul_f32 v[38:39], v[154:155], s[62:63]
    v_exp_f32 v36, v36
    v_exp_f32 v37, v37
    v_exp_f32 v38, v38
    v_exp_f32 v39, v39
    v_pk_mul_f32 v[152:153], v[152:153], v[168:169]
    v_pk_mul_f32 v[154:155], v[154:155], v[170:171]
    v_pk_add_f32 v[36:37], v[36:37], s[64:65]
    v_pk_add_f32 v[38:39], v[38:39], s[64:65]
    v_rcp_f32 v36, v36
    v_rcp_f32 v37, v37
    v_rcp_f32 v38, v38
    v_rcp_f32 v39, v39
    s_nop 0
    v_pk_mul_f32 v[152:153], v[152:153], v[36:37]
    v_pk_mul_f32 v[154:155], v[154:155], v[38:39]
    v_cvt_pk_bf16_f32 v58, v152, v153
    v_cvt_pk_bf16_f32 v59, v154, v155
    s_add_u32 s52, s58, 2
    s_mul_i32 s52, s52, 57344
    s_add_u32 s52, s52, s53
    buffer_store_dwordx4 v[56:59], v9, s[20:23], s52 offen
    v_pk_mul_f32 v[32:33], v[124:125], s[62:63]
    v_pk_mul_f32 v[34:35], v[126:127], s[62:63]
    v_exp_f32 v32, v32
    v_exp_f32 v33, v33
    v_exp_f32 v34, v34
    v_exp_f32 v35, v35
    v_pk_mul_f32 v[124:125], v[124:125], v[140:141]
    v_pk_mul_f32 v[126:127], v[126:127], v[142:143]
    v_pk_add_f32 v[32:33], v[32:33], s[64:65]
    v_pk_add_f32 v[34:35], v[34:35], s[64:65]
    v_rcp_f32 v32, v32
    v_rcp_f32 v33, v33
    v_rcp_f32 v34, v34
    v_rcp_f32 v35, v35
    s_nop 0
    v_pk_mul_f32 v[124:125], v[124:125], v[32:33]
    v_pk_mul_f32 v[126:127], v[126:127], v[34:35]
    v_cvt_pk_bf16_f32 v60, v124, v125
    v_cvt_pk_bf16_f32 v61, v126, v127
    v_pk_mul_f32 v[36:37], v[156:157], s[62:63]
    v_pk_mul_f32 v[38:39], v[158:159], s[62:63]
    v_exp_f32 v36, v36
    v_exp_f32 v37, v37
    v_exp_f32 v38, v38
    v_exp_f32 v39, v39
    v_pk_mul_f32 v[156:157], v[156:157], v[172:173]
    v_pk_mul_f32 v[158:159], v[158:159], v[174:175]
    v_pk_add_f32 v[36:37], v[36:37], s[64:65]
    v_pk_add_f32 v[38:39], v[38:39], s[64:65]
    v_rcp_f32 v36, v36
    v_rcp_f32 v37, v37
    v_rcp_f32 v38, v38
    v_rcp_f32 v39, v39
    s_nop 0
    v_pk_mul_f32 v[156:157], v[156:157], v[36:37]
    v_pk_mul_f32 v[158:159], v[158:159], v[38:39]
    v_cvt_pk_bf16_f32 v62, v156, v157
    v_cvt_pk_bf16_f32 v63, v158, v159
    s_add_u32 s52, s58, 3
    s_mul_i32 s52, s52, 57344
    s_add_u32 s52, s52, s53
    buffer_store_dwordx4 v[60:63], v9, s[20:23], s52 offen
    s_mul_i32 s53, s56, 5
    s_add_u32 s53, s53, 20
    s_lshl_b32 s53, s53, 10
    s_lshr_b32 s54, s50, 1
    s_lshl_b32 s54, s54, 3
    s_add_u32 s53, s53, s54
    v_pk_mul_f32 v[32:33], v[176:177], s[62:63]
    v_pk_mul_f32 v[34:35], v[178:179], s[62:63]
    v_exp_f32 v32, v32
    v_exp_f32 v33, v33
    v_exp_f32 v34, v34
    v_exp_f32 v35, v35
    v_pk_mul_f32 v[176:177], v[176:177], v[192:193]
    v_pk_mul_f32 v[178:179], v[178:179], v[194:195]
    v_pk_add_f32 v[32:33], v[32:33], s[64:65]
    v_pk_add_f32 v[34:35], v[34:35], s[64:65]
    v_rcp_f32 v32, v32
    v_rcp_f32 v33, v33
    v_rcp_f32 v34, v34
    v_rcp_f32 v35, v35
    s_nop 0
    v_pk_mul_f32 v[176:177], v[176:177], v[32:33]
    v_pk_mul_f32 v[178:179], v[178:179], v[34:35]
    v_cvt_pk_bf16_f32 v64, v176, v177
    v_cvt_pk_bf16_f32 v65, v178, v179
    s_add_u32 s52, s58, 0
    s_mul_i32 s52, s52, 57344
    s_add_u32 s52, s52, s53
    buffer_store_dwordx2 v[64:65], v9, s[20:23], s52 offen
    v_pk_mul_f32 v[36:37], v[180:181], s[62:63]
    v_pk_mul_f32 v[38:39], v[182:183], s[62:63]
    v_exp_f32 v36, v36
    v_exp_f32 v37, v37
    v_exp_f32 v38, v38
    v_exp_f32 v39, v39
    v_pk_mul_f32 v[180:181], v[180:181], v[196:197]
    v_pk_mul_f32 v[182:183], v[182:183], v[198:199]
    v_pk_add_f32 v[36:37], v[36:37], s[64:65]
    v_pk_add_f32 v[38:39], v[38:39], s[64:65]
    v_rcp_f32 v36, v36
    v_rcp_f32 v37, v37
    v_rcp_f32 v38, v38
    v_rcp_f32 v39, v39
    s_nop 0
    v_pk_mul_f32 v[180:181], v[180:181], v[36:37]
    v_pk_mul_f32 v[182:183], v[182:183], v[38:39]
    v_cvt_pk_bf16_f32 v66, v180, v181
    v_cvt_pk_bf16_f32 v67, v182, v183
    s_add_u32 s52, s58, 1
    s_mul_i32 s52, s52, 57344
    s_add_u32 s52, s52, s53
    buffer_store_dwordx2 v[66:67], v9, s[20:23], s52 offen
    v_pk_mul_f32 v[32:33], v[184:185], s[62:63]
    v_pk_mul_f32 v[34:35], v[186:187], s[62:63]
    v_exp_f32 v32, v32
    v_exp_f32 v33, v33
    v_exp_f32 v34, v34
    v_exp_f32 v35, v35
    v_pk_mul_f32 v[184:185], v[184:185], v[200:201]
    v_pk_mul_f32 v[186:187], v[186:187], v[202:203]
    v_pk_add_f32 v[32:33], v[32:33], s[64:65]
    v_pk_add_f32 v[34:35], v[34:35], s[64:65]
    v_rcp_f32 v32, v32
    v_rcp_f32 v33, v33
    v_rcp_f32 v34, v34
    v_rcp_f32 v35, v35
    s_nop 0
    v_pk_mul_f32 v[184:185], v[184:185], v[32:33]
    v_pk_mul_f32 v[186:187], v[186:187], v[34:35]
    v_cvt_pk_bf16_f32 v68, v184, v185
    v_cvt_pk_bf16_f32 v69, v186, v187
    s_add_u32 s52, s58, 2
    s_mul_i32 s52, s52, 57344
    s_add_u32 s52, s52, s53
    buffer_store_dwordx2 v[68:69], v9, s[20:23], s52 offen
    v_pk_mul_f32 v[36:37], v[188:189], s[62:63]
    v_pk_mul_f32 v[38:39], v[190:191], s[62:63]
    v_exp_f32 v36, v36
    v_exp_f32 v37, v37
    v_exp_f32 v38, v38
    v_exp_f32 v39, v39
    v_pk_mul_f32 v[188:189], v[188:189], v[204:205]
    v_pk_mul_f32 v[190:191], v[190:191], v[206:207]
    v_pk_add_f32 v[36:37], v[36:37], s[64:65]
    v_pk_add_f32 v[38:39], v[38:39], s[64:65]
    v_rcp_f32 v36, v36
    v_rcp_f32 v37, v37
    v_rcp_f32 v38, v38
    v_rcp_f32 v39, v39
    s_nop 0
    v_pk_mul_f32 v[188:189], v[188:189], v[36:37]
    v_pk_mul_f32 v[190:191], v[190:191], v[38:39]
    v_cvt_pk_bf16_f32 v70, v188, v189
    v_cvt_pk_bf16_f32 v71, v190, v191
    s_add_u32 s52, s58, 3
    s_mul_i32 s52, s52, 57344
    s_add_u32 s52, s52, s53
    buffer_store_dwordx2 v[70:71], v9, s[20:23], s52 offen
    s_branch K1_END
K1_QKV6:
    s_and_b32 s52, s50, 2
    s_add_u32 s53, s52, 0
    v_lshrrev_b32 v24, 4, v1
    v_lshrrev_b32 v25, 2, v1
    v_and_b32 v25, 3, v25
    v_and_b32 v26, 3, v1
    v_lshlrev_b32 v12, 3, v26
    v_and_b32 v26, 1, v24
    v_lshl_add_u32 v12, v24, 10, v12
    v_lshl_add_u32 v12, v25, 7, v12
    v_lshrrev_b32 v27, 1, v25
    v_lshl_or_b32 v27, v26, 1, v27
    v_xor_b32 v27, s53, v27
    v_lshl_add_u32 v12, v27, 5, v12
    s_add_u32 s53, s52, 1
    v_lshrrev_b32 v24, 4, v1
    v_lshrrev_b32 v25, 2, v1
    v_and_b32 v25, 3, v25
    v_and_b32 v26, 3, v1
    v_lshlrev_b32 v13, 3, v26
    v_and_b32 v26, 1, v24
    v_lshl_add_u32 v13, v24, 10, v13
    v_lshl_add_u32 v13, v25, 7, v13
    v_lshrrev_b32 v27, 1, v25
    v_lshl_or_b32 v27, v26, 1, v27
    v_xor_b32 v27, s53, v27
    v_lshl_add_u32 v13, v27, 5, v13
    v_add_u32 v14, 4096, v12
    v_add_u32 v15, 4096, v13
    v_add_u32 v16, 8192, v12
    v_add_u32 v17, 8192, v13
    v_add_u32 v18, 40960, v12
    v_add_u32 v19, 40960, v13
    v_add_u32 v20, 40960, v14
    v_add_u32 v21, 40960, v15
    v_add_u32 v22, 40960, v16
    v_add_u32 v23, 40960, v17
    s_cmp_eq_u32 s50, 0
    s_cselect_b32 s53, s4, s6
    s_cselect_b32 s54, s5, s7
    s_cmp_eq_u32 s50, 2
    s_cselect_b32 s53, s8, s53
    s_cselect_b32 s54, s9, s54
    s_cmp_eq_u32 s50, 3
    s_cselect_b32 s53, s10, s53
    s_cselect_b32 s54, s11, s54
    s_mov_b32 s28, s53
    s_and_b32 s29, s54, 0xffff
    s_mov_b32 s55, 1204224
    s_cmp_eq_u32 s50, 1
    s_cselect_b32 s30, s55, 1605632
    s_mov_b32 s55, 1835008
    s_cmp_eq_u32 s50, 0
    s_cselect_b32 s30, s55, s30
    s_mov_b32 s31, 0x00020000
    s_mov_b32 s55, 7
    s_cmp_eq_u32 s50, 1
    s_cselect_b32 s55, 6, s55
    s_cmp_eq_u32 s50, 0
    s_cselect_b32 s55, 8, s55
    s_mul_i32 s52, s2, s55
    s_mul_i32 s53, s2, 21
    s_lshr_b32 s53, s53, 2
    s_cmp_eq_u32 s50, 1
    s_cselect_b32 s52, s53, s52
    s_mov_b32 s53, 128
    s_cmp_eq_u32 s50, 0
    s_cselect_b32 s53, 896, s53
    v_add_u32 v24, s52, v1
    v_mul_lo_u32 v24, v24, s53
    v_mov_b32 v25, 0x7ffffff0
    v_cmp_gt_u32 vcc, s55, v1
    s_nop 1
    v_cndmask_b32 v2, v25, v24, vcc
    s_mov_b32 s55, 229376
    s_mov_b32 s53, 172032
    s_cmp_eq_u32 s50, 1
    s_cselect_b32 s55, s53, s55
    s_cmp_eq_u32 s50, 0
    s_cselect_b32 s4, 128, s55
    s_mov_b32 s68, 0
    s_mul_i32 s52, s4, 0
    s_add_u32 s52, s52, s68
    buffer_load_dword v211, v2, s[28:31], s52 offen
    s_mul_i32 s52, s4, 1
    s_add_u32 s52, s52, s68
    buffer_load_dword v211, v2, s[28:31], s52 offen
    s_mul_i32 s52, s4, 2
    s_add_u32 s52, s52, s68
    buffer_load_dword v211, v2, s[28:31], s52 offen
    s_waitcnt vmcnt(3)
    v_mov_b32 v11, 0
    v_lshlrev_b32 v24, 16, v96
    v_and_b32 v25, s60, v96
    v_lshlrev_b32 v26, 16, v100
    v_and_b32 v27, s60, v100
    v_pk_mul_f32 v[24:25], v[24:25], v[26:27]
    v_cvt_pk_bf16_f32 v28, v24, v25
    v_lshlrev_b32 v24, 16, v28
    v_and_b32 v25, s60, v28
    v_add_f32 v11, v11, v24
    v_add_f32 v11, v11, v25
    v_lshlrev_b32 v24, 16, v97
    v_and_b32 v25, s60, v97
    v_lshlrev_b32 v26, 16, v101
    v_and_b32 v27, s60, v101
    v_pk_mul_f32 v[24:25], v[24:25], v[26:27]
    v_cvt_pk_bf16_f32 v28, v24, v25
    v_lshlrev_b32 v24, 16, v28
    v_and_b32 v25, s60, v28
    v_add_f32 v11, v11, v24
    v_add_f32 v11, v11, v25
    v_lshlrev_b32 v24, 16, v98
    v_and_b32 v25, s60, v98
    v_lshlrev_b32 v26, 16, v102
    v_and_b32 v27, s60, v102
    v_pk_mul_f32 v[24:25], v[24:25], v[26:27]
    v_cvt_pk_bf16_f32 v28, v24, v25
    v_lshlrev_b32 v24, 16, v28
    v_and_b32 v25, s60, v28
    v_add_f32 v11, v11, v24
    v_add_f32 v11, v11, v25
    v_lshlrev_b32 v24, 16, v99
    v_and_b32 v25, s60, v99
    v_lshlrev_b32 v26, 16, v103
    v_and_b32 v27, s60, v103
    v_pk_mul_f32 v[24:25], v[24:25], v[26:27]
    v_cvt_pk_bf16_f32 v28, v24, v25
    v_lshlrev_b32 v24, 16, v28
    v_and_b32 v25, s60, v28
    v_add_f32 v11, v11, v24
    v_add_f32 v11, v11, v25
    s_nop 1
    v_add_f32_dpp v11, v11, v11 quad_perm:[1,0,3,2] row_mask:0xf bank_mask:0xf
    s_nop 1
    v_add_f32_dpp v11, v11, v11 quad_perm:[2,3,0,1] row_mask:0xf bank_mask:0xf
    s_nop 1
    v_add_f32_dpp v11, v11, v11 row_half_mirror row_mask:0xf bank_mask:0xf
    s_nop 1
    v_add_f32_dpp v11, v11, v11 row_mirror row_mask:0xf bank_mask:0xf
    s_nop 1
    v_readlane_b32 s52, v11, 16
    v_readlane_b32 s53, v11, 32
    v_readlane_b32 s54, v11, 48
    s_nop 1
    v_add_f32 v11, s52, v11
    v_add_f32 v11, s53, v11
    v_add_f32 v11, s54, v11
    v_cvt_pk_bf16_f32 v11, v11, v11
    v_lshlrev_b32 v11, 16, v11
    v_mul_f32 v11, s62, v11
    v_exp_f32 v11, v11
    s_nop 0
    v_add_f32 v11, 1.0, v11
    v_rcp_f32 v11, v11
    s_nop 0
    v_cvt_pk_bf16_f32 v11, v11, v11
    v_lshlrev_b32 v11, 16, v11
    s_barrier
    ds_read_b128 v[32:35], v9 offset:0
    ds_read_b128 v[36:39], v9 offset:2048
    ds_read_b128 v[40:43], v9 offset:4096
    ds_read_b128 v[44:47], v9 offset:6144
    ds_read_b64_tr_b16 v[64:65], v12 offset:0
    ds_read_b64_tr_b16 v[66:67], v12 offset:512
    ds_read_b64_tr_b16 v[68:69], v13 offset:0
    ds_read_b64_tr_b16 v[70:71], v13 offset:512
    ds_read_b64_tr_b16 v[72:73], v14 offset:0
    ds_read_b64_tr_b16 v[74:75], v14 offset:512
    ds_read_b64_tr_b16 v[76:77], v15 offset:0
    ds_read_b64_tr_b16 v[78:79], v15 offset:512
    ds_read_b64_tr_b16 v[80:81], v16 offset:0
    ds_read_b64_tr_b16 v[82:83], v16 offset:512
    ds_read_b64_tr_b16 v[84:85], v17 offset:0
    ds_read_b64_tr_b16 v[86:87], v17 offset:512
    s_waitcnt lgkmcnt(0)
    s_barrier
    s_mul_i32 s52, s4, 3
    s_add_u32 s52, s52, s68
    buffer_load_dword v211, v2, s[28:31], s52 offen
    v_mfma_f32_16x16x32_bf16 v[112:115], v[64:67], v[32:35], 0
    ds_read_b128 v[48:51], v10 offset:0
    v_mfma_f32_16x16x32_bf16 v[116:119], v[64:67], v[36:39], 0
    ds_read_b128 v[52:55], v10 offset:2048
    v_mfma_f32_16x16x32_bf16 v[120:123], v[64:67], v[40:43], 0
    ds_read_b128 v[56:59], v10 offset:4096
    v_mfma_f32_16x16x32_bf16 v[124:127], v[64:67], v[44:47], 0
    ds_read_b128 v[60:63], v10 offset:6144
    v_mfma_f32_16x16x32_bf16 v[128:131], v[68:71], v[32:35], 0
    ds_read_b64_tr_b16 v[88:89], v12 offset:20480
    v_mfma_f32_16x16x32_bf16 v[132:135], v[68:71], v[36:39], 0
    ds_read_b64_tr_b16 v[90:91], v12 offset:20992
    v_mfma_f32_16x16x32_bf16 v[136:139], v[68:71], v[40:43], 0
    ds_read_b64_tr_b16 v[92:93], v13 offset:20480
    v_mfma_f32_16x16x32_bf16 v[140:143], v[68:71], v[44:47], 0
    ds_read_b64_tr_b16 v[94:95], v13 offset:20992
    v_mfma_f32_16x16x32_bf16 v[144:147], v[32:35], v[72:75], 0
    ds_read_b64_tr_b16 v[96:97], v14 offset:20480
    v_mfma_f32_16x16x32_bf16 v[148:151], v[36:39], v[72:75], 0
    ds_read_b64_tr_b16 v[98:99], v14 offset:20992
    v_mfma_f32_16x16x32_bf16 v[152:155], v[40:43], v[72:75], 0
    ds_read_b64_tr_b16 v[100:101], v15 offset:20480
    v_mfma_f32_16x16x32_bf16 v[156:159], v[44:47], v[72:75], 0
    ds_read_b64_tr_b16 v[102:103], v15 offset:20992
    v_mfma_f32_16x16x32_bf16 v[160:163], v[32:35], v[76:79], 0
    ds_read_b64_tr_b16 v[104:105], v16 offset:20480
    v_mfma_f32_16x16x32_bf16 v[164:167], v[36:39], v[76:79], 0
    ds_read_b64_tr_b16 v[106:107], v16 offset:20992
    v_mfma_f32_16x16x32_bf16 v[168:171], v[40:43], v[76:79], 0
    ds_read_b64_tr_b16 v[108:109], v17 offset:20480
    v_mfma_f32_16x16x32_bf16 v[172:175], v[44:47], v[76:79], 0
    ds_read_b64_tr_b16 v[110:111], v17 offset:20992
    v_mfma_f32_16x16x32_bf16 v[176:179], v[32:35], v[80:83], 0
    v_mfma_f32_16x16x32_bf16 v[180:183], v[36:39], v[80:83], 0
    v_mfma_f32_16x16x32_bf16 v[184:187], v[40:43], v[80:83], 0
    v_mfma_f32_16x16x32_bf16 v[188:191], v[44:47], v[80:83], 0
    v_mfma_f32_16x16x32_bf16 v[192:195], v[32:35], v[84:87], 0
    v_mfma_f32_16x16x32_bf16 v[196:199], v[36:39], v[84:87], 0
    v_mfma_f32_16x16x32_bf16 v[200:203], v[40:43], v[84:87], 0
    v_mfma_f32_16x16x32_bf16 v[204:207], v[44:47], v[84:87], 0
    s_waitcnt lgkmcnt(0)
    s_barrier
    s_mul_i32 s52, s4, 4
    s_add_u32 s52, s52, s68
    buffer_load_dword v211, v2, s[28:31], s52 offen
    v_mfma_f32_16x16x32_bf16 v[112:115], v[88:91], v[48:51], v[112:115]
    ds_read_b128 v[32:35], v9 offset:16384
    v_mfma_f32_16x16x32_bf16 v[116:119], v[88:91], v[52:55], v[116:119]
    ds_read_b128 v[36:39], v9 offset:18432
    v_mfma_f32_16x16x32_bf16 v[120:123], v[88:91], v[56:59], v[120:123]
    ds_read_b128 v[40:43], v9 offset:20480
    v_mfma_f32_16x16x32_bf16 v[124:127], v[88:91], v[60:63], v[124:127]
    ds_read_b128 v[44:47], v9 offset:22528
    v_mfma_f32_16x16x32_bf16 v[128:131], v[92:95], v[48:51], v[128:131]
    ds_read_b64_tr_b16 v[64:65], v18 offset:0
    v_mfma_f32_16x16x32_bf16 v[132:135], v[92:95], v[52:55], v[132:135]
    ds_read_b64_tr_b16 v[66:67], v18 offset:512
    v_mfma_f32_16x16x32_bf16 v[136:139], v[92:95], v[56:59], v[136:139]
    ds_read_b64_tr_b16 v[68:69], v19 offset:0
    v_mfma_f32_16x16x32_bf16 v[140:143], v[92:95], v[60:63], v[140:143]
    ds_read_b64_tr_b16 v[70:71], v19 offset:512
    v_mfma_f32_16x16x32_bf16 v[144:147], v[48:51], v[96:99], v[144:147]
    ds_read_b64_tr_b16 v[72:73], v20 offset:0
    v_mfma_f32_16x16x32_bf16 v[148:151], v[52:55], v[96:99], v[148:151]
    ds_read_b64_tr_b16 v[74:75], v20 offset:512
    v_mfma_f32_16x16x32_bf16 v[152:155], v[56:59], v[96:99], v[152:155]
    ds_read_b64_tr_b16 v[76:77], v21 offset:0
    v_mfma_f32_16x16x32_bf16 v[156:159], v[60:63], v[96:99], v[156:159]
    ds_read_b64_tr_b16 v[78:79], v21 offset:512
    v_mfma_f32_16x16x32_bf16 v[160:163], v[48:51], v[100:103], v[160:163]
    ds_read_b64_tr_b16 v[80:81], v22 offset:0
    v_mfma_f32_16x16x32_bf16 v[164:167], v[52:55], v[100:103], v[164:167]
    ds_read_b64_tr_b16 v[82:83], v22 offset:512
    v_mfma_f32_16x16x32_bf16 v[168:171], v[56:59], v[100:103], v[168:171]
    ds_read_b64_tr_b16 v[84:85], v23 offset:0
    v_mfma_f32_16x16x32_bf16 v[172:175], v[60:63], v[100:103], v[172:175]
    ds_read_b64_tr_b16 v[86:87], v23 offset:512
    v_mfma_f32_16x16x32_bf16 v[176:179], v[48:51], v[104:107], v[176:179]
    v_mfma_f32_16x16x32_bf16 v[180:183], v[52:55], v[104:107], v[180:183]
    v_mfma_f32_16x16x32_bf16 v[184:187], v[56:59], v[104:107], v[184:187]
    v_mfma_f32_16x16x32_bf16 v[188:191], v[60:63], v[104:107], v[188:191]
    v_mfma_f32_16x16x32_bf16 v[192:195], v[48:51], v[108:111], v[192:195]
    v_mfma_f32_16x16x32_bf16 v[196:199], v[52:55], v[108:111], v[196:199]
    v_mfma_f32_16x16x32_bf16 v[200:203], v[56:59], v[108:111], v[200:203]
    v_mfma_f32_16x16x32_bf16 v[204:207], v[60:63], v[108:111], v[204:207]
    s_waitcnt lgkmcnt(0)
    s_barrier
    s_mul_i32 s52, s4, 5
    s_add_u32 s52, s52, s68
    buffer_load_dword v211, v2, s[28:31], s52 offen
    v_mfma_f32_16x16x32_bf16 v[112:115], v[64:67], v[32:35], v[112:115]
    ds_read_b128 v[48:51], v10 offset:16384
    v_mfma_f32_16x16x32_bf16 v[116:119], v[64:67], v[36:39], v[116:119]
    ds_read_b128 v[52:55], v10 offset:18432
    v_mfma_f32_16x16x32_bf16 v[120:123], v[64:67], v[40:43], v[120:123]
    ds_read_b128 v[56:59], v10 offset:20480
    v_mfma_f32_16x16x32_bf16 v[124:127], v[64:67], v[44:47], v[124:127]
    ds_read_b128 v[60:63], v10 offset:22528
    v_mfma_f32_16x16x32_bf16 v[128:131], v[68:71], v[32:35], v[128:131]
    ds_read_b64_tr_b16 v[88:89], v18 offset:20480
    v_mfma_f32_16x16x32_bf16 v[132:135], v[68:71], v[36:39], v[132:135]
    ds_read_b64_tr_b16 v[90:91], v18 offset:20992
    v_mfma_f32_16x16x32_bf16 v[136:139], v[68:71], v[40:43], v[136:139]
    ds_read_b64_tr_b16 v[92:93], v19 offset:20480
    v_mfma_f32_16x16x32_bf16 v[140:143], v[68:71], v[44:47], v[140:143]
    ds_read_b64_tr_b16 v[94:95], v19 offset:20992
    v_mfma_f32_16x16x32_bf16 v[144:147], v[32:35], v[72:75], v[144:147]
    ds_read_b64_tr_b16 v[96:97], v20 offset:20480
    v_mfma_f32_16x16x32_bf16 v[148:151], v[36:39], v[72:75], v[148:151]
    ds_read_b64_tr_b16 v[98:99], v20 offset:20992
    v_mfma_f32_16x16x32_bf16 v[152:155], v[40:43], v[72:75], v[152:155]
    ds_read_b64_tr_b16 v[100:101], v21 offset:20480
    v_mfma_f32_16x16x32_bf16 v[156:159], v[44:47], v[72:75], v[156:159]
    ds_read_b64_tr_b16 v[102:103], v21 offset:20992
    v_mfma_f32_16x16x32_bf16 v[160:163], v[32:35], v[76:79], v[160:163]
    ds_read_b64_tr_b16 v[104:105], v22 offset:20480
    v_mfma_f32_16x16x32_bf16 v[164:167], v[36:39], v[76:79], v[164:167]
    ds_read_b64_tr_b16 v[106:107], v22 offset:20992
    v_mfma_f32_16x16x32_bf16 v[168:171], v[40:43], v[76:79], v[168:171]
    ds_read_b64_tr_b16 v[108:109], v23 offset:20480
    v_mfma_f32_16x16x32_bf16 v[172:175], v[44:47], v[76:79], v[172:175]
    ds_read_b64_tr_b16 v[110:111], v23 offset:20992
    v_mfma_f32_16x16x32_bf16 v[176:179], v[32:35], v[80:83], v[176:179]
    v_mfma_f32_16x16x32_bf16 v[180:183], v[36:39], v[80:83], v[180:183]
    v_mfma_f32_16x16x32_bf16 v[184:187], v[40:43], v[80:83], v[184:187]
    v_mfma_f32_16x16x32_bf16 v[188:191], v[44:47], v[80:83], v[188:191]
    v_mfma_f32_16x16x32_bf16 v[192:195], v[32:35], v[84:87], v[192:195]
    v_mfma_f32_16x16x32_bf16 v[196:199], v[36:39], v[84:87], v[196:199]
    v_mfma_f32_16x16x32_bf16 v[200:203], v[40:43], v[84:87], v[200:203]
    v_mfma_f32_16x16x32_bf16 v[204:207], v[44:47], v[84:87], v[204:207]
    s_waitcnt lgkmcnt(0)
    s_barrier
    s_mul_i32 s52, s4, 6
    s_add_u32 s52, s52, s68
    buffer_load_dword v211, v2, s[28:31], s52 offen
    v_mfma_f32_16x16x32_bf16 v[112:115], v[88:91], v[48:51], v[112:115]
    ds_read_b128 v[32:35], v9 offset:0
    v_mfma_f32_16x16x32_bf16 v[116:119], v[88:91], v[52:55], v[116:119]
    ds_read_b128 v[36:39], v9 offset:2048
    v_mfma_f32_16x16x32_bf16 v[120:123], v[88:91], v[56:59], v[120:123]
    ds_read_b128 v[40:43], v9 offset:4096
    v_mfma_f32_16x16x32_bf16 v[124:127], v[88:91], v[60:63], v[124:127]
    ds_read_b128 v[44:47], v9 offset:6144
    v_mfma_f32_16x16x32_bf16 v[128:131], v[92:95], v[48:51], v[128:131]
    ds_read_b64_tr_b16 v[64:65], v12 offset:0
    v_mfma_f32_16x16x32_bf16 v[132:135], v[92:95], v[52:55], v[132:135]
    ds_read_b64_tr_b16 v[66:67], v12 offset:512
    v_mfma_f32_16x16x32_bf16 v[136:139], v[92:95], v[56:59], v[136:139]
    ds_read_b64_tr_b16 v[68:69], v13 offset:0
    v_mfma_f32_16x16x32_bf16 v[140:143], v[92:95], v[60:63], v[140:143]
    ds_read_b64_tr_b16 v[70:71], v13 offset:512
    v_mfma_f32_16x16x32_bf16 v[144:147], v[48:51], v[96:99], v[144:147]
    ds_read_b64_tr_b16 v[72:73], v14 offset:0
    v_mfma_f32_16x16x32_bf16 v[148:151], v[52:55], v[96:99], v[148:151]
    ds_read_b64_tr_b16 v[74:75], v14 offset:512
    v_mfma_f32_16x16x32_bf16 v[152:155], v[56:59], v[96:99], v[152:155]
    ds_read_b64_tr_b16 v[76:77], v15 offset:0
    v_mfma_f32_16x16x32_bf16 v[156:159], v[60:63], v[96:99], v[156:159]
    ds_read_b64_tr_b16 v[78:79], v15 offset:512
    v_mfma_f32_16x16x32_bf16 v[160:163], v[48:51], v[100:103], v[160:163]
    ds_read_b64_tr_b16 v[80:81], v16 offset:0
    v_mfma_f32_16x16x32_bf16 v[164:167], v[52:55], v[100:103], v[164:167]
    ds_read_b64_tr_b16 v[82:83], v16 offset:512
    v_mfma_f32_16x16x32_bf16 v[168:171], v[56:59], v[100:103], v[168:171]
    ds_read_b64_tr_b16 v[84:85], v17 offset:0
    v_mfma_f32_16x16x32_bf16 v[172:175], v[60:63], v[100:103], v[172:175]
    ds_read_b64_tr_b16 v[86:87], v17 offset:512
    v_mfma_f32_16x16x32_bf16 v[176:179], v[48:51], v[104:107], v[176:179]
    v_mfma_f32_16x16x32_bf16 v[180:183], v[52:55], v[104:107], v[180:183]
    v_mfma_f32_16x16x32_bf16 v[184:187], v[56:59], v[104:107], v[184:187]
    v_mfma_f32_16x16x32_bf16 v[188:191], v[60:63], v[104:107], v[188:191]
    v_mfma_f32_16x16x32_bf16 v[192:195], v[48:51], v[108:111], v[192:195]
    v_mfma_f32_16x16x32_bf16 v[196:199], v[52:55], v[108:111], v[196:199]
    v_mfma_f32_16x16x32_bf16 v[200:203], v[56:59], v[108:111], v[200:203]
    v_mfma_f32_16x16x32_bf16 v[204:207], v[60:63], v[108:111], v[204:207]
    s_waitcnt lgkmcnt(0)
    s_barrier
    v_mfma_f32_16x16x32_bf16 v[112:115], v[64:67], v[32:35], v[112:115]
    ds_read_b128 v[48:51], v10 offset:0
    v_mfma_f32_16x16x32_bf16 v[116:119], v[64:67], v[36:39], v[116:119]
    ds_read_b128 v[52:55], v10 offset:2048
    v_mfma_f32_16x16x32_bf16 v[120:123], v[64:67], v[40:43], v[120:123]
    ds_read_b128 v[56:59], v10 offset:4096
    v_mfma_f32_16x16x32_bf16 v[124:127], v[64:67], v[44:47], v[124:127]
    ds_read_b128 v[60:63], v10 offset:6144
    v_mfma_f32_16x16x32_bf16 v[128:131], v[68:71], v[32:35], v[128:131]
    ds_read_b64_tr_b16 v[88:89], v12 offset:20480
    v_mfma_f32_16x16x32_bf16 v[132:135], v[68:71], v[36:39], v[132:135]
    ds_read_b64_tr_b16 v[90:91], v12 offset:20992
    v_mfma_f32_16x16x32_bf16 v[136:139], v[68:71], v[40:43], v[136:139]
    ds_read_b64_tr_b16 v[92:93], v13 offset:20480
    v_mfma_f32_16x16x32_bf16 v[140:143], v[68:71], v[44:47], v[140:143]
    ds_read_b64_tr_b16 v[94:95], v13 offset:20992
    v_mfma_f32_16x16x32_bf16 v[144:147], v[32:35], v[72:75], v[144:147]
    ds_read_b64_tr_b16 v[96:97], v14 offset:20480
    v_mfma_f32_16x16x32_bf16 v[148:151], v[36:39], v[72:75], v[148:151]
    ds_read_b64_tr_b16 v[98:99], v14 offset:20992
    v_mfma_f32_16x16x32_bf16 v[152:155], v[40:43], v[72:75], v[152:155]
    ds_read_b64_tr_b16 v[100:101], v15 offset:20480
    v_mfma_f32_16x16x32_bf16 v[156:159], v[44:47], v[72:75], v[156:159]
    ds_read_b64_tr_b16 v[102:103], v15 offset:20992
    v_mfma_f32_16x16x32_bf16 v[160:163], v[32:35], v[76:79], v[160:163]
    ds_read_b64_tr_b16 v[104:105], v16 offset:20480
    v_mfma_f32_16x16x32_bf16 v[164:167], v[36:39], v[76:79], v[164:167]
    ds_read_b64_tr_b16 v[106:107], v16 offset:20992
    v_mfma_f32_16x16x32_bf16 v[168:171], v[40:43], v[76:79], v[168:171]
    ds_read_b64_tr_b16 v[108:109], v17 offset:20480
    v_mfma_f32_16x16x32_bf16 v[172:175], v[44:47], v[76:79], v[172:175]
    ds_read_b64_tr_b16 v[110:111], v17 offset:20992
    v_mfma_f32_16x16x32_bf16 v[176:179], v[32:35], v[80:83], v[176:179]
    v_mfma_f32_16x16x32_bf16 v[180:183], v[36:39], v[80:83], v[180:183]
    v_mfma_f32_16x16x32_bf16 v[184:187], v[40:43], v[80:83], v[184:187]
    v_mfma_f32_16x16x32_bf16 v[188:191], v[44:47], v[80:83], v[188:191]
    v_mfma_f32_16x16x32_bf16 v[192:195], v[32:35], v[84:87], v[192:195]
    v_mfma_f32_16x16x32_bf16 v[196:199], v[36:39], v[84:87], v[196:199]
    v_mfma_f32_16x16x32_bf16 v[200:203], v[40:43], v[84:87], v[200:203]
    v_mfma_f32_16x16x32_bf16 v[204:207], v[44:47], v[84:87], v[204:207]
    s_waitcnt lgkmcnt(0)
    s_barrier
    v_mfma_f32_16x16x32_bf16 v[112:115], v[88:91], v[48:51], v[112:115]
    ds_read_b128 v[32:35], v9 offset:16384
    v_mfma_f32_16x16x32_bf16 v[116:119], v[88:91], v[52:55], v[116:119]
    ds_read_b128 v[36:39], v9 offset:18432
    v_mfma_f32_16x16x32_bf16 v[120:123], v[88:91], v[56:59], v[120:123]
    ds_read_b128 v[40:43], v9 offset:20480
    v_mfma_f32_16x16x32_bf16 v[124:127], v[88:91], v[60:63], v[124:127]
    ds_read_b128 v[44:47], v9 offset:22528
    v_mfma_f32_16x16x32_bf16 v[128:131], v[92:95], v[48:51], v[128:131]
    ds_read_b64_tr_b16 v[64:65], v18 offset:0
    v_mfma_f32_16x16x32_bf16 v[132:135], v[92:95], v[52:55], v[132:135]
    ds_read_b64_tr_b16 v[66:67], v18 offset:512
    v_mfma_f32_16x16x32_bf16 v[136:139], v[92:95], v[56:59], v[136:139]
    ds_read_b64_tr_b16 v[68:69], v19 offset:0
    v_mfma_f32_16x16x32_bf16 v[140:143], v[92:95], v[60:63], v[140:143]
    ds_read_b64_tr_b16 v[70:71], v19 offset:512
    v_mfma_f32_16x16x32_bf16 v[144:147], v[48:51], v[96:99], v[144:147]
    ds_read_b64_tr_b16 v[72:73], v20 offset:0
    v_mfma_f32_16x16x32_bf16 v[148:151], v[52:55], v[96:99], v[148:151]
    ds_read_b64_tr_b16 v[74:75], v20 offset:512
    v_mfma_f32_16x16x32_bf16 v[152:155], v[56:59], v[96:99], v[152:155]
    ds_read_b64_tr_b16 v[76:77], v21 offset:0
    v_mfma_f32_16x16x32_bf16 v[156:159], v[60:63], v[96:99], v[156:159]
    ds_read_b64_tr_b16 v[78:79], v21 offset:512
    v_mfma_f32_16x16x32_bf16 v[160:163], v[48:51], v[100:103], v[160:163]
    ds_read_b64_tr_b16 v[80:81], v22 offset:0
    v_mfma_f32_16x16x32_bf16 v[164:167], v[52:55], v[100:103], v[164:167]
    ds_read_b64_tr_b16 v[82:83], v22 offset:512
    v_mfma_f32_16x16x32_bf16 v[168:171], v[56:59], v[100:103], v[168:171]
    ds_read_b64_tr_b16 v[84:85], v23 offset:0
    v_mfma_f32_16x16x32_bf16 v[172:175], v[60:63], v[100:103], v[172:175]
    ds_read_b64_tr_b16 v[86:87], v23 offset:512
    v_mfma_f32_16x16x32_bf16 v[176:179], v[48:51], v[104:107], v[176:179]
    v_mfma_f32_16x16x32_bf16 v[180:183], v[52:55], v[104:107], v[180:183]
    v_mfma_f32_16x16x32_bf16 v[184:187], v[56:59], v[104:107], v[184:187]
    v_mfma_f32_16x16x32_bf16 v[188:191], v[60:63], v[104:107], v[188:191]
    v_mfma_f32_16x16x32_bf16 v[192:195], v[48:51], v[108:111], v[192:195]
    v_mfma_f32_16x16x32_bf16 v[196:199], v[52:55], v[108:111], v[196:199]
    v_mfma_f32_16x16x32_bf16 v[200:203], v[56:59], v[108:111], v[200:203]
    v_mfma_f32_16x16x32_bf16 v[204:207], v[60:63], v[108:111], v[204:207]
    s_waitcnt lgkmcnt(0)
    s_barrier
    v_mfma_f32_16x16x32_bf16 v[112:115], v[64:67], v[32:35], v[112:115]
    ds_read_b128 v[48:51], v10 offset:16384
    v_mfma_f32_16x16x32_bf16 v[116:119], v[64:67], v[36:39], v[116:119]
    ds_read_b128 v[52:55], v10 offset:18432
    v_mfma_f32_16x16x32_bf16 v[120:123], v[64:67], v[40:43], v[120:123]
    ds_read_b128 v[56:59], v10 offset:20480
    v_mfma_f32_16x16x32_bf16 v[124:127], v[64:67], v[44:47], v[124:127]
    ds_read_b128 v[60:63], v10 offset:22528
    v_mfma_f32_16x16x32_bf16 v[128:131], v[68:71], v[32:35], v[128:131]
    ds_read_b64_tr_b16 v[88:89], v18 offset:20480
    v_mfma_f32_16x16x32_bf16 v[132:135], v[68:71], v[36:39], v[132:135]
    ds_read_b64_tr_b16 v[90:91], v18 offset:20992
    v_mfma_f32_16x16x32_bf16 v[136:139], v[68:71], v[40:43], v[136:139]
    ds_read_b64_tr_b16 v[92:93], v19 offset:20480
    v_mfma_f32_16x16x32_bf16 v[140:143], v[68:71], v[44:47], v[140:143]
    ds_read_b64_tr_b16 v[94:95], v19 offset:20992
    v_mfma_f32_16x16x32_bf16 v[144:147], v[32:35], v[72:75], v[144:147]
    ds_read_b64_tr_b16 v[96:97], v20 offset:20480
    v_mfma_f32_16x16x32_bf16 v[148:151], v[36:39], v[72:75], v[148:151]
    ds_read_b64_tr_b16 v[98:99], v20 offset:20992
    v_mfma_f32_16x16x32_bf16 v[152:155], v[40:43], v[72:75], v[152:155]
    ds_read_b64_tr_b16 v[100:101], v21 offset:20480
    v_mfma_f32_16x16x32_bf16 v[156:159], v[44:47], v[72:75], v[156:159]
    ds_read_b64_tr_b16 v[102:103], v21 offset:20992
    v_mfma_f32_16x16x32_bf16 v[160:163], v[32:35], v[76:79], v[160:163]
    ds_read_b64_tr_b16 v[104:105], v22 offset:20480
    v_mfma_f32_16x16x32_bf16 v[164:167], v[36:39], v[76:79], v[164:167]
    ds_read_b64_tr_b16 v[106:107], v22 offset:20992
    v_mfma_f32_16x16x32_bf16 v[168:171], v[40:43], v[76:79], v[168:171]
    ds_read_b64_tr_b16 v[108:109], v23 offset:20480
    v_mfma_f32_16x16x32_bf16 v[172:175], v[44:47], v[76:79], v[172:175]
    ds_read_b64_tr_b16 v[110:111], v23 offset:20992
    v_mfma_f32_16x16x32_bf16 v[176:179], v[32:35], v[80:83], v[176:179]
    v_mfma_f32_16x16x32_bf16 v[180:183], v[36:39], v[80:83], v[180:183]
    v_mfma_f32_16x16x32_bf16 v[184:187], v[40:43], v[80:83], v[184:187]
    v_mfma_f32_16x16x32_bf16 v[188:191], v[44:47], v[80:83], v[188:191]
    v_mfma_f32_16x16x32_bf16 v[192:195], v[32:35], v[84:87], v[192:195]
    v_mfma_f32_16x16x32_bf16 v[196:199], v[36:39], v[84:87], v[196:199]
    v_mfma_f32_16x16x32_bf16 v[200:203], v[40:43], v[84:87], v[200:203]
    v_mfma_f32_16x16x32_bf16 v[204:207], v[44:47], v[84:87], v[204:207]
    s_waitcnt lgkmcnt(0)
    s_barrier
    v_mfma_f32_16x16x32_bf16 v[112:115], v[88:91], v[48:51], v[112:115]
    ds_read_b128 v[32:35], v9 offset:0
    v_mfma_f32_16x16x32_bf16 v[116:119], v[88:91], v[52:55], v[116:119]
    ds_read_b128 v[36:39], v9 offset:2048
    v_mfma_f32_16x16x32_bf16 v[120:123], v[88:91], v[56:59], v[120:123]
    ds_read_b128 v[40:43], v9 offset:4096
    v_mfma_f32_16x16x32_bf16 v[124:127], v[88:91], v[60:63], v[124:127]
    ds_read_b128 v[44:47], v9 offset:6144
    v_mfma_f32_16x16x32_bf16 v[128:131], v[92:95], v[48:51], v[128:131]
    ds_read_b64_tr_b16 v[64:65], v12 offset:0
    v_mfma_f32_16x16x32_bf16 v[132:135], v[92:95], v[52:55], v[132:135]
    ds_read_b64_tr_b16 v[66:67], v12 offset:512
    v_mfma_f32_16x16x32_bf16 v[136:139], v[92:95], v[56:59], v[136:139]
    ds_read_b64_tr_b16 v[68:69], v13 offset:0
    v_mfma_f32_16x16x32_bf16 v[140:143], v[92:95], v[60:63], v[140:143]
    ds_read_b64_tr_b16 v[70:71], v13 offset:512
    v_mfma_f32_16x16x32_bf16 v[144:147], v[48:51], v[96:99], v[144:147]
    ds_read_b64_tr_b16 v[72:73], v14 offset:0
    v_mfma_f32_16x16x32_bf16 v[148:151], v[52:55], v[96:99], v[148:151]
    ds_read_b64_tr_b16 v[74:75], v14 offset:512
    v_mfma_f32_16x16x32_bf16 v[152:155], v[56:59], v[96:99], v[152:155]
    ds_read_b64_tr_b16 v[76:77], v15 offset:0
    v_mfma_f32_16x16x32_bf16 v[156:159], v[60:63], v[96:99], v[156:159]
    ds_read_b64_tr_b16 v[78:79], v15 offset:512
    v_mfma_f32_16x16x32_bf16 v[160:163], v[48:51], v[100:103], v[160:163]
    ds_read_b64_tr_b16 v[80:81], v16 offset:0
    v_mfma_f32_16x16x32_bf16 v[164:167], v[52:55], v[100:103], v[164:167]
    ds_read_b64_tr_b16 v[82:83], v16 offset:512
    v_mfma_f32_16x16x32_bf16 v[168:171], v[56:59], v[100:103], v[168:171]
    ds_read_b64_tr_b16 v[84:85], v17 offset:0
    v_mfma_f32_16x16x32_bf16 v[172:175], v[60:63], v[100:103], v[172:175]
    ds_read_b64_tr_b16 v[86:87], v17 offset:512
    v_mfma_f32_16x16x32_bf16 v[176:179], v[48:51], v[104:107], v[176:179]
    v_mfma_f32_16x16x32_bf16 v[180:183], v[52:55], v[104:107], v[180:183]
    v_mfma_f32_16x16x32_bf16 v[184:187], v[56:59], v[104:107], v[184:187]
    v_mfma_f32_16x16x32_bf16 v[188:191], v[60:63], v[104:107], v[188:191]
    v_mfma_f32_16x16x32_bf16 v[192:195], v[48:51], v[108:111], v[192:195]
    v_mfma_f32_16x16x32_bf16 v[196:199], v[52:55], v[108:111], v[196:199]
    v_mfma_f32_16x16x32_bf16 v[200:203], v[56:59], v[108:111], v[200:203]
    v_mfma_f32_16x16x32_bf16 v[204:207], v[60:63], v[108:111], v[204:207]
    s_waitcnt lgkmcnt(0)
    s_barrier
    v_mfma_f32_16x16x32_bf16 v[112:115], v[64:67], v[32:35], v[112:115]
    ds_read_b128 v[48:51], v10 offset:0
    v_mfma_f32_16x16x32_bf16 v[116:119], v[64:67], v[36:39], v[116:119]
    ds_read_b128 v[52:55], v10 offset:2048
    v_mfma_f32_16x16x32_bf16 v[120:123], v[64:67], v[40:43], v[120:123]
    ds_read_b128 v[56:59], v10 offset:4096
    v_mfma_f32_16x16x32_bf16 v[124:127], v[64:67], v[44:47], v[124:127]
    ds_read_b128 v[60:63], v10 offset:6144
    v_mfma_f32_16x16x32_bf16 v[128:131], v[68:71], v[32:35], v[128:131]
    ds_read_b64_tr_b16 v[88:89], v12 offset:20480
    v_mfma_f32_16x16x32_bf16 v[132:135], v[68:71], v[36:39], v[132:135]
    ds_read_b64_tr_b16 v[90:91], v12 offset:20992
    v_mfma_f32_16x16x32_bf16 v[136:139], v[68:71], v[40:43], v[136:139]
    ds_read_b64_tr_b16 v[92:93], v13 offset:20480
    v_mfma_f32_16x16x32_bf16 v[140:143], v[68:71], v[44:47], v[140:143]
    ds_read_b64_tr_b16 v[94:95], v13 offset:20992
    v_mfma_f32_16x16x32_bf16 v[144:147], v[32:35], v[72:75], v[144:147]
    ds_read_b64_tr_b16 v[96:97], v14 offset:20480
    v_mfma_f32_16x16x32_bf16 v[148:151], v[36:39], v[72:75], v[148:151]
    ds_read_b64_tr_b16 v[98:99], v14 offset:20992
    v_mfma_f32_16x16x32_bf16 v[152:155], v[40:43], v[72:75], v[152:155]
    ds_read_b64_tr_b16 v[100:101], v15 offset:20480
    v_mfma_f32_16x16x32_bf16 v[156:159], v[44:47], v[72:75], v[156:159]
    ds_read_b64_tr_b16 v[102:103], v15 offset:20992
    v_mfma_f32_16x16x32_bf16 v[160:163], v[32:35], v[76:79], v[160:163]
    ds_read_b64_tr_b16 v[104:105], v16 offset:20480
    v_mfma_f32_16x16x32_bf16 v[164:167], v[36:39], v[76:79], v[164:167]
    ds_read_b64_tr_b16 v[106:107], v16 offset:20992
    v_mfma_f32_16x16x32_bf16 v[168:171], v[40:43], v[76:79], v[168:171]
    ds_read_b64_tr_b16 v[108:109], v17 offset:20480
    v_mfma_f32_16x16x32_bf16 v[172:175], v[44:47], v[76:79], v[172:175]
    ds_read_b64_tr_b16 v[110:111], v17 offset:20992
    v_mfma_f32_16x16x32_bf16 v[176:179], v[32:35], v[80:83], v[176:179]
    v_mfma_f32_16x16x32_bf16 v[180:183], v[36:39], v[80:83], v[180:183]
    v_mfma_f32_16x16x32_bf16 v[184:187], v[40:43], v[80:83], v[184:187]
    v_mfma_f32_16x16x32_bf16 v[188:191], v[44:47], v[80:83], v[188:191]
    v_mfma_f32_16x16x32_bf16 v[192:195], v[32:35], v[84:87], v[192:195]
    v_mfma_f32_16x16x32_bf16 v[196:199], v[36:39], v[84:87], v[196:199]
    v_mfma_f32_16x16x32_bf16 v[200:203], v[40:43], v[84:87], v[200:203]
    v_mfma_f32_16x16x32_bf16 v[204:207], v[44:47], v[84:87], v[204:207]
    s_waitcnt lgkmcnt(0)
    s_barrier
    v_mfma_f32_16x16x32_bf16 v[112:115], v[88:91], v[48:51], v[112:115]
    ds_read_b128 v[32:35], v9 offset:16384
    v_mfma_f32_16x16x32_bf16 v[116:119], v[88:91], v[52:55], v[116:119]
    ds_read_b128 v[36:39], v9 offset:18432
    v_mfma_f32_16x16x32_bf16 v[120:123], v[88:91], v[56:59], v[120:123]
    ds_read_b128 v[40:43], v9 offset:20480
    v_mfma_f32_16x16x32_bf16 v[124:127], v[88:91], v[60:63], v[124:127]
    ds_read_b128 v[44:47], v9 offset:22528
    v_mfma_f32_16x16x32_bf16 v[128:131], v[92:95], v[48:51], v[128:131]
    ds_read_b64_tr_b16 v[64:65], v18 offset:0
    v_mfma_f32_16x16x32_bf16 v[132:135], v[92:95], v[52:55], v[132:135]
    ds_read_b64_tr_b16 v[66:67], v18 offset:512
    v_mfma_f32_16x16x32_bf16 v[136:139], v[92:95], v[56:59], v[136:139]
    ds_read_b64_tr_b16 v[68:69], v19 offset:0
    v_mfma_f32_16x16x32_bf16 v[140:143], v[92:95], v[60:63], v[140:143]
    ds_read_b64_tr_b16 v[70:71], v19 offset:512
    v_mfma_f32_16x16x32_bf16 v[144:147], v[48:51], v[96:99], v[144:147]
    ds_read_b64_tr_b16 v[72:73], v20 offset:0
    v_mfma_f32_16x16x32_bf16 v[148:151], v[52:55], v[96:99], v[148:151]
    ds_read_b64_tr_b16 v[74:75], v20 offset:512
    v_mfma_f32_16x16x32_bf16 v[152:155], v[56:59], v[96:99], v[152:155]
    ds_read_b64_tr_b16 v[76:77], v21 offset:0
    v_mfma_f32_16x16x32_bf16 v[156:159], v[60:63], v[96:99], v[156:159]
    ds_read_b64_tr_b16 v[78:79], v21 offset:512
    v_mfma_f32_16x16x32_bf16 v[160:163], v[48:51], v[100:103], v[160:163]
    ds_read_b64_tr_b16 v[80:81], v22 offset:0
    v_mfma_f32_16x16x32_bf16 v[164:167], v[52:55], v[100:103], v[164:167]
    ds_read_b64_tr_b16 v[82:83], v22 offset:512
    v_mfma_f32_16x16x32_bf16 v[168:171], v[56:59], v[100:103], v[168:171]
    ds_read_b64_tr_b16 v[84:85], v23 offset:0
    v_mfma_f32_16x16x32_bf16 v[172:175], v[60:63], v[100:103], v[172:175]
    ds_read_b64_tr_b16 v[86:87], v23 offset:512
    v_mfma_f32_16x16x32_bf16 v[176:179], v[48:51], v[104:107], v[176:179]
    v_mfma_f32_16x16x32_bf16 v[180:183], v[52:55], v[104:107], v[180:183]
    v_mfma_f32_16x16x32_bf16 v[184:187], v[56:59], v[104:107], v[184:187]
    v_mfma_f32_16x16x32_bf16 v[188:191], v[60:63], v[104:107], v[188:191]
    v_mfma_f32_16x16x32_bf16 v[192:195], v[48:51], v[108:111], v[192:195]
    v_mfma_f32_16x16x32_bf16 v[196:199], v[52:55], v[108:111], v[196:199]
    v_mfma_f32_16x16x32_bf16 v[200:203], v[56:59], v[108:111], v[200:203]
    v_mfma_f32_16x16x32_bf16 v[204:207], v[60:63], v[108:111], v[204:207]
    s_waitcnt lgkmcnt(0)
    s_barrier
    v_mfma_f32_16x16x32_bf16 v[112:115], v[64:67], v[32:35], v[112:115]
    ds_read_b128 v[48:51], v10 offset:16384
    v_mfma_f32_16x16x32_bf16 v[116:119], v[64:67], v[36:39], v[116:119]
    ds_read_b128 v[52:55], v10 offset:18432
    v_mfma_f32_16x16x32_bf16 v[120:123], v[64:67], v[40:43], v[120:123]
    ds_read_b128 v[56:59], v10 offset:20480
    v_mfma_f32_16x16x32_bf16 v[124:127], v[64:67], v[44:47], v[124:127]
    ds_read_b128 v[60:63], v10 offset:22528
    v_mfma_f32_16x16x32_bf16 v[128:131], v[68:71], v[32:35], v[128:131]
    ds_read_b64_tr_b16 v[88:89], v18 offset:20480
    v_mfma_f32_16x16x32_bf16 v[132:135], v[68:71], v[36:39], v[132:135]
    ds_read_b64_tr_b16 v[90:91], v18 offset:20992
    v_mfma_f32_16x16x32_bf16 v[136:139], v[68:71], v[40:43], v[136:139]
    ds_read_b64_tr_b16 v[92:93], v19 offset:20480
    v_mfma_f32_16x16x32_bf16 v[140:143], v[68:71], v[44:47], v[140:143]
    ds_read_b64_tr_b16 v[94:95], v19 offset:20992
    v_mfma_f32_16x16x32_bf16 v[144:147], v[32:35], v[72:75], v[144:147]
    ds_read_b64_tr_b16 v[96:97], v20 offset:20480
    v_mfma_f32_16x16x32_bf16 v[148:151], v[36:39], v[72:75], v[148:151]
    ds_read_b64_tr_b16 v[98:99], v20 offset:20992
    v_mfma_f32_16x16x32_bf16 v[152:155], v[40:43], v[72:75], v[152:155]
    ds_read_b64_tr_b16 v[100:101], v21 offset:20480
    v_mfma_f32_16x16x32_bf16 v[156:159], v[44:47], v[72:75], v[156:159]
    ds_read_b64_tr_b16 v[102:103], v21 offset:20992
    v_mfma_f32_16x16x32_bf16 v[160:163], v[32:35], v[76:79], v[160:163]
    ds_read_b64_tr_b16 v[104:105], v22 offset:20480
    v_mfma_f32_16x16x32_bf16 v[164:167], v[36:39], v[76:79], v[164:167]
    ds_read_b64_tr_b16 v[106:107], v22 offset:20992
    v_mfma_f32_16x16x32_bf16 v[168:171], v[40:43], v[76:79], v[168:171]
    ds_read_b64_tr_b16 v[108:109], v23 offset:20480
    v_mfma_f32_16x16x32_bf16 v[172:175], v[44:47], v[76:79], v[172:175]
    ds_read_b64_tr_b16 v[110:111], v23 offset:20992
    v_mfma_f32_16x16x32_bf16 v[176:179], v[32:35], v[80:83], v[176:179]
    v_mfma_f32_16x16x32_bf16 v[180:183], v[36:39], v[80:83], v[180:183]
    v_mfma_f32_16x16x32_bf16 v[184:187], v[40:43], v[80:83], v[184:187]
    v_mfma_f32_16x16x32_bf16 v[188:191], v[44:47], v[80:83], v[188:191]
    v_mfma_f32_16x16x32_bf16 v[192:195], v[32:35], v[84:87], v[192:195]
    v_mfma_f32_16x16x32_bf16 v[196:199], v[36:39], v[84:87], v[196:199]
    v_mfma_f32_16x16x32_bf16 v[200:203], v[40:43], v[84:87], v[200:203]
    v_mfma_f32_16x16x32_bf16 v[204:207], v[44:47], v[84:87], v[204:207]
    s_waitcnt lgkmcnt(0)
    s_barrier
    s_setprio 2
    v_mfma_f32_16x16x32_bf16 v[112:115], v[88:91], v[48:51], v[112:115]
    ds_read_b128 v[32:35], v9 offset:0
    v_mfma_f32_16x16x32_bf16 v[116:119], v[88:91], v[52:55], v[116:119]
    ds_read_b128 v[36:39], v9 offset:2048
    v_mfma_f32_16x16x32_bf16 v[120:123], v[88:91], v[56:59], v[120:123]
    ds_read_b128 v[40:43], v9 offset:4096
    v_mfma_f32_16x16x32_bf16 v[124:127], v[88:91], v[60:63], v[124:127]
    ds_read_b128 v[44:47], v9 offset:6144
    v_mfma_f32_16x16x32_bf16 v[128:131], v[92:95], v[48:51], v[128:131]
    ds_read_b64_tr_b16 v[64:65], v12 offset:0
    v_mfma_f32_16x16x32_bf16 v[132:135], v[92:95], v[52:55], v[132:135]
    ds_read_b64_tr_b16 v[66:67], v12 offset:512
    v_mfma_f32_16x16x32_bf16 v[136:139], v[92:95], v[56:59], v[136:139]
    ds_read_b64_tr_b16 v[68:69], v13 offset:0
    v_mfma_f32_16x16x32_bf16 v[140:143], v[92:95], v[60:63], v[140:143]
    ds_read_b64_tr_b16 v[70:71], v13 offset:512
    v_mfma_f32_16x16x32_bf16 v[144:147], v[48:51], v[96:99], v[144:147]
    ds_read_b64_tr_b16 v[72:73], v14 offset:0
    v_mfma_f32_16x16x32_bf16 v[148:151], v[52:55], v[96:99], v[148:151]
    ds_read_b64_tr_b16 v[74:75], v14 offset:512
    v_mfma_f32_16x16x32_bf16 v[152:155], v[56:59], v[96:99], v[152:155]
    ds_read_b64_tr_b16 v[76:77], v15 offset:0
    v_mfma_f32_16x16x32_bf16 v[156:159], v[60:63], v[96:99], v[156:159]
    ds_read_b64_tr_b16 v[78:79], v15 offset:512
    v_mfma_f32_16x16x32_bf16 v[160:163], v[48:51], v[100:103], v[160:163]
    ds_read_b64_tr_b16 v[80:81], v16 offset:0
    v_mfma_f32_16x16x32_bf16 v[164:167], v[52:55], v[100:103], v[164:167]
    ds_read_b64_tr_b16 v[82:83], v16 offset:512
    v_mfma_f32_16x16x32_bf16 v[168:171], v[56:59], v[100:103], v[168:171]
    ds_read_b64_tr_b16 v[84:85], v17 offset:0
    v_mfma_f32_16x16x32_bf16 v[172:175], v[60:63], v[100:103], v[172:175]
    ds_read_b64_tr_b16 v[86:87], v17 offset:512
    v_mfma_f32_16x16x32_bf16 v[176:179], v[48:51], v[104:107], v[176:179]
    v_mfma_f32_16x16x32_bf16 v[180:183], v[52:55], v[104:107], v[180:183]
    v_mfma_f32_16x16x32_bf16 v[184:187], v[56:59], v[104:107], v[184:187]
    v_mfma_f32_16x16x32_bf16 v[188:191], v[60:63], v[104:107], v[188:191]
    v_mfma_f32_16x16x32_bf16 v[192:195], v[48:51], v[108:111], v[192:195]
    v_mfma_f32_16x16x32_bf16 v[196:199], v[52:55], v[108:111], v[196:199]
    v_mfma_f32_16x16x32_bf16 v[200:203], v[56:59], v[108:111], v[200:203]
    v_mfma_f32_16x16x32_bf16 v[204:207], v[60:63], v[108:111], v[204:207]
    s_waitcnt lgkmcnt(0)
    s_barrier
    s_mov_b32 s24, s96
    s_and_b32 s25, s97, 0xffff
    s_mov_b32 s26, 0x188000
    s_mov_b32 s27, 0x00020000
    s_lshl_b32 s52, s2, 2
    s_add_u32 s52, s52, s50
    s_mul_i32 s53, s52, 1664
    v_lshlrev_b32 v24, 7, v1
    v_mov_b32 v25, 0x7ffffff0
    v_cmp_gt_u32 vcc, 13, v1
    s_nop 1
    v_cndmask_b32 v26, v25, v24, vcc
    buffer_load_dword v208, v26, s[24:27], s53 offen
    s_mov_b32 s32, s98
    s_and_b32 s33, s99, 0xffff
    s_mov_b32 s34, 0x62000
    s_mov_b32 s35, 0x00020000
    s_mul_i32 s53, s52, 512
    v_cmp_gt_u32 vcc, 4, v1
    s_nop 1
    v_cndmask_b32 v26, v25, v24, vcc
    buffer_load_dword v210, v26, s[32:35], s53 offen
    v_mfma_f32_16x16x32_bf16 v[112:115], v[64:67], v[32:35], v[112:115]
    ds_read_b128 v[48:51], v10 offset:0
    v_mfma_f32_16x16x32_bf16 v[116:119], v[64:67], v[36:39], v[116:119]
    ds_read_b128 v[52:55], v10 offset:2048
    v_mfma_f32_16x16x32_bf16 v[120:123], v[64:67], v[40:43], v[120:123]
    ds_read_b128 v[56:59], v10 offset:4096
    v_mfma_f32_16x16x32_bf16 v[124:127], v[64:67], v[44:47], v[124:127]
    ds_read_b128 v[60:63], v10 offset:6144
    v_mfma_f32_16x16x32_bf16 v[128:131], v[68:71], v[32:35], v[128:131]
    ds_read_b64_tr_b16 v[88:89], v12 offset:20480
    v_mfma_f32_16x16x32_bf16 v[132:135], v[68:71], v[36:39], v[132:135]
    ds_read_b64_tr_b16 v[90:91], v12 offset:20992
    v_mfma_f32_16x16x32_bf16 v[136:139], v[68:71], v[40:43], v[136:139]
    ds_read_b64_tr_b16 v[92:93], v13 offset:20480
    v_mfma_f32_16x16x32_bf16 v[140:143], v[68:71], v[44:47], v[140:143]
    ds_read_b64_tr_b16 v[94:95], v13 offset:20992
    v_mfma_f32_16x16x32_bf16 v[144:147], v[32:35], v[72:75], v[144:147]
    ds_read_b64_tr_b16 v[96:97], v14 offset:20480
    v_mfma_f32_16x16x32_bf16 v[148:151], v[36:39], v[72:75], v[148:151]
    ds_read_b64_tr_b16 v[98:99], v14 offset:20992
    v_mfma_f32_16x16x32_bf16 v[152:155], v[40:43], v[72:75], v[152:155]
    ds_read_b64_tr_b16 v[100:101], v15 offset:20480
    v_mfma_f32_16x16x32_bf16 v[156:159], v[44:47], v[72:75], v[156:159]
    ds_read_b64_tr_b16 v[102:103], v15 offset:20992
    v_mfma_f32_16x16x32_bf16 v[160:163], v[32:35], v[76:79], v[160:163]
    ds_read_b64_tr_b16 v[104:105], v16 offset:20480
    v_mfma_f32_16x16x32_bf16 v[164:167], v[36:39], v[76:79], v[164:167]
    ds_read_b64_tr_b16 v[106:107], v16 offset:20992
    v_mfma_f32_16x16x32_bf16 v[168:171], v[40:43], v[76:79], v[168:171]
    ds_read_b64_tr_b16 v[108:109], v17 offset:20480
    v_mfma_f32_16x16x32_bf16 v[172:175], v[44:47], v[76:79], v[172:175]
    ds_read_b64_tr_b16 v[110:111], v17 offset:20992
    v_mfma_f32_16x16x32_bf16 v[176:179], v[32:35], v[80:83], v[176:179]
    v_mfma_f32_16x16x32_bf16 v[180:183], v[36:39], v[80:83], v[180:183]
    v_mfma_f32_16x16x32_bf16 v[184:187], v[40:43], v[80:83], v[184:187]
    v_mfma_f32_16x16x32_bf16 v[188:191], v[44:47], v[80:83], v[188:191]
    v_mfma_f32_16x16x32_bf16 v[192:195], v[32:35], v[84:87], v[192:195]
    v_mfma_f32_16x16x32_bf16 v[196:199], v[36:39], v[84:87], v[196:199]
    v_mfma_f32_16x16x32_bf16 v[200:203], v[40:43], v[84:87], v[200:203]
    v_mfma_f32_16x16x32_bf16 v[204:207], v[44:47], v[84:87], v[204:207]
    s_waitcnt lgkmcnt(0)
    v_mfma_f32_16x16x32_bf16 v[112:115], v[88:91], v[48:51], v[112:115]
    v_mfma_f32_16x16x32_bf16 v[116:119], v[88:91], v[52:55], v[116:119]
    v_mfma_f32_16x16x32_bf16 v[120:123], v[88:91], v[56:59], v[120:123]
    v_mfma_f32_16x16x32_bf16 v[124:127], v[88:91], v[60:63], v[124:127]
    v_mfma_f32_16x16x32_bf16 v[128:131], v[92:95], v[48:51], v[128:131]
    v_mfma_f32_16x16x32_bf16 v[132:135], v[92:95], v[52:55], v[132:135]
    v_mfma_f32_16x16x32_bf16 v[136:139], v[92:95], v[56:59], v[136:139]
    v_mfma_f32_16x16x32_bf16 v[140:143], v[92:95], v[60:63], v[140:143]
    v_mfma_f32_16x16x32_bf16 v[144:147], v[48:51], v[96:99], v[144:147]
    v_mfma_f32_16x16x32_bf16 v[148:151], v[52:55], v[96:99], v[148:151]
    v_mfma_f32_16x16x32_bf16 v[152:155], v[56:59], v[96:99], v[152:155]
    v_mfma_f32_16x16x32_bf16 v[156:159], v[60:63], v[96:99], v[156:159]
    v_mfma_f32_16x16x32_bf16 v[160:163], v[48:51], v[100:103], v[160:163]
    v_mfma_f32_16x16x32_bf16 v[164:167], v[52:55], v[100:103], v[164:167]
    v_mfma_f32_16x16x32_bf16 v[168:171], v[56:59], v[100:103], v[168:171]
    v_mfma_f32_16x16x32_bf16 v[172:175], v[60:63], v[100:103], v[172:175]
    v_mfma_f32_16x16x32_bf16 v[176:179], v[48:51], v[104:107], v[176:179]
    v_mfma_f32_16x16x32_bf16 v[180:183], v[52:55], v[104:107], v[180:183]
    v_mfma_f32_16x16x32_bf16 v[184:187], v[56:59], v[104:107], v[184:187]
    v_mfma_f32_16x16x32_bf16 v[188:191], v[60:63], v[104:107], v[188:191]
    v_mfma_f32_16x16x32_bf16 v[192:195], v[48:51], v[108:111], v[192:195]
    v_mfma_f32_16x16x32_bf16 v[196:199], v[52:55], v[108:111], v[196:199]
    v_mfma_f32_16x16x32_bf16 v[200:203], v[56:59], v[108:111], v[200:203]
    v_mfma_f32_16x16x32_bf16 v[204:207], v[60:63], v[108:111], v[204:207]
    s_mov_b32 s10, 0x3fb8aa3b
    s_mov_b32 s11, 0x3fb8aa3b
    s_mov_b32 s12, 0x358637bd
    s_mov_b32 s13, 0x358637bd
    s_nop 5
    v_mov_b32 v25, 0x7ffffff0
    v_mov_b32 v24, 11599872
    v_cmp_eq_u32 vcc, 0, v1
    s_nop 1
    v_cndmask_b32 v24, v25, v24, vcc
    buffer_store_dword v11, v24, s[20:23], s59 offen
    v_lshlrev_b32 v9, 4, v1
    s_lshl_b32 s55, s56, 1
    s_lshr_b32 s52, s50, 1
    s_add_u32 s55, s55, s52
    v_cmp_gt_u32 vcc, 48, v1
    s_nop 1
    v_cndmask_b32 v2, 0, -1, vcc
    v_and_b32 v24, 15, v1
    v_cmp_gt_u32 vcc, 12, v24
    s_nop 1
    v_cndmask_b32 v3, 0, -1, vcc
    v_mov_b32 v25, 0x3f803f80
    v_cmp_eq_u32 vcc, 12, v24
    s_nop 1
    v_cndmask_b32 v4, 0, v25, vcc
    v_pk_mul_f32 v[36:37], v[112:113], s[10:11]
    v_pk_mul_f32 v[38:39], v[114:115], s[10:11]
    v_exp_f32_e64 v36, v36 clamp
    v_exp_f32_e64 v37, v37 clamp
    v_exp_f32_e64 v38, v38 clamp
    v_exp_f32_e64 v39, v39 clamp
    v_max_f32 v32, 0, v112
    v_max_f32 v33, 0, v113
    v_max_f32 v34, 0, v114
    v_max_f32 v35, 0, v115
    v_pk_add_f32 v[32:33], v[32:33], v[36:37]
    v_pk_add_f32 v[34:35], v[34:35], v[38:39]
    v_pk_add_f32 v[32:33], v[32:33], s[12:13]
    v_pk_add_f32 v[34:35], v[34:35], s[12:13]
    v_cvt_pk_bf16_f32 v48, v32, v33
    v_cvt_pk_bf16_f32 v49, v34, v35
    v_pk_mul_f32 v[36:37], v[128:129], s[10:11]
    v_pk_mul_f32 v[38:39], v[130:131], s[10:11]
    v_exp_f32_e64 v36, v36 clamp
    v_exp_f32_e64 v37, v37 clamp
    v_exp_f32_e64 v38, v38 clamp
    v_exp_f32_e64 v39, v39 clamp
    v_max_f32 v32, 0, v128
    v_max_f32 v33, 0, v129
    v_max_f32 v34, 0, v130
    v_max_f32 v35, 0, v131
    v_pk_add_f32 v[32:33], v[32:33], v[36:37]
    v_pk_add_f32 v[34:35], v[34:35], v[38:39]
    v_pk_add_f32 v[32:33], v[32:33], s[12:13]
    v_pk_add_f32 v[34:35], v[34:35], s[12:13]
    v_cvt_pk_bf16_f32 v50, v32, v33
    v_cvt_pk_bf16_f32 v51, v34, v35
    v_and_b32 v50, v50, v2
    v_and_b32 v51, v51, v2
    s_add_u32 s52, s58, 0
    s_lshl_b32 s52, s52, 4
    s_add_u32 s52, s52, s55
    s_lshl_b32 s52, s52, 10
    s_add_u32 s52, s52, 7340032
    buffer_store_dwordx4 v[48:51], v9, s[20:23], s52 offen
    v_pk_mul_f32 v[36:37], v[116:117], s[10:11]
    v_pk_mul_f32 v[38:39], v[118:119], s[10:11]
    v_exp_f32_e64 v36, v36 clamp
    v_exp_f32_e64 v37, v37 clamp
    v_exp_f32_e64 v38, v38 clamp
    v_exp_f32_e64 v39, v39 clamp
    v_max_f32 v32, 0, v116
    v_max_f32 v33, 0, v117
    v_max_f32 v34, 0, v118
    v_max_f32 v35, 0, v119
    v_pk_add_f32 v[32:33], v[32:33], v[36:37]
    v_pk_add_f32 v[34:35], v[34:35], v[38:39]
    v_pk_add_f32 v[32:33], v[32:33], s[12:13]
    v_pk_add_f32 v[34:35], v[34:35], s[12:13]
    v_cvt_pk_bf16_f32 v52, v32, v33
    v_cvt_pk_bf16_f32 v53, v34, v35
    v_pk_mul_f32 v[36:37], v[132:133], s[10:11]
    v_pk_mul_f32 v[38:39], v[134:135], s[10:11]
    v_exp_f32_e64 v36, v36 clamp
    v_exp_f32_e64 v37, v37 clamp
    v_exp_f32_e64 v38, v38 clamp
    v_exp_f32_e64 v39, v39 clamp
    v_max_f32 v32, 0, v132
    v_max_f32 v33, 0, v133
    v_max_f32 v34, 0, v134
    v_max_f32 v35, 0, v135
    v_pk_add_f32 v[32:33], v[32:33], v[36:37]
    v_pk_add_f32 v[34:35], v[34:35], v[38:39]
    v_pk_add_f32 v[32:33], v[32:33], s[12:13]
    v_pk_add_f32 v[34:35], v[34:35], s[12:13]
    v_cvt_pk_bf16_f32 v54, v32, v33
    v_cvt_pk_bf16_f32 v55, v34, v35
    v_and_b32 v54, v54, v2
    v_and_b32 v55, v55, v2
    s_add_u32 s52, s58, 1
    s_lshl_b32 s52, s52, 4
    s_add_u32 s52, s52, s55
    s_lshl_b32 s52, s52, 10
    s_add_u32 s52, s52, 7340032
    buffer_store_dwordx4 v[52:55], v9, s[20:23], s52 offen
    v_pk_mul_f32 v[36:37], v[120:121], s[10:11]
    v_pk_mul_f32 v[38:39], v[122:123], s[10:11]
    v_exp_f32_e64 v36, v36 clamp
    v_exp_f32_e64 v37, v37 clamp
    v_exp_f32_e64 v38, v38 clamp
    v_exp_f32_e64 v39, v39 clamp
    v_max_f32 v32, 0, v120
    v_max_f32 v33, 0, v121
    v_max_f32 v34, 0, v122
    v_max_f32 v35, 0, v123
    v_pk_add_f32 v[32:33], v[32:33], v[36:37]
    v_pk_add_f32 v[34:35], v[34:35], v[38:39]
    v_pk_add_f32 v[32:33], v[32:33], s[12:13]
    v_pk_add_f32 v[34:35], v[34:35], s[12:13]
    v_cvt_pk_bf16_f32 v56, v32, v33
    v_cvt_pk_bf16_f32 v57, v34, v35
    v_pk_mul_f32 v[36:37], v[136:137], s[10:11]
    v_pk_mul_f32 v[38:39], v[138:139], s[10:11]
    v_exp_f32_e64 v36, v36 clamp
    v_exp_f32_e64 v37, v37 clamp
    v_exp_f32_e64 v38, v38 clamp
    v_exp_f32_e64 v39, v39 clamp
    v_max_f32 v32, 0, v136
    v_max_f32 v33, 0, v137
    v_max_f32 v34, 0, v138
    v_max_f32 v35, 0, v139
    v_pk_add_f32 v[32:33], v[32:33], v[36:37]
    v_pk_add_f32 v[34:35], v[34:35], v[38:39]
    v_pk_add_f32 v[32:33], v[32:33], s[12:13]
    v_pk_add_f32 v[34:35], v[34:35], s[12:13]
    v_cvt_pk_bf16_f32 v58, v32, v33
    v_cvt_pk_bf16_f32 v59, v34, v35
    v_and_b32 v58, v58, v2
    v_and_b32 v59, v59, v2
    s_add_u32 s52, s58, 2
    s_lshl_b32 s52, s52, 4
    s_add_u32 s52, s52, s55
    s_lshl_b32 s52, s52, 10
    s_add_u32 s52, s52, 7340032
    buffer_store_dwordx4 v[56:59], v9, s[20:23], s52 offen
    v_pk_mul_f32 v[36:37], v[124:125], s[10:11]
    v_pk_mul_f32 v[38:39], v[126:127], s[10:11]
    v_exp_f32_e64 v36, v36 clamp
    v_exp_f32_e64 v37, v37 clamp
    v_exp_f32_e64 v38, v38 clamp
    v_exp_f32_e64 v39, v39 clamp
    v_max_f32 v32, 0, v124
    v_max_f32 v33, 0, v125
    v_max_f32 v34, 0, v126
    v_max_f32 v35, 0, v127
    v_pk_add_f32 v[32:33], v[32:33], v[36:37]
    v_pk_add_f32 v[34:35], v[34:35], v[38:39]
    v_pk_add_f32 v[32:33], v[32:33], s[12:13]
    v_pk_add_f32 v[34:35], v[34:35], s[12:13]
    v_cvt_pk_bf16_f32 v60, v32, v33
    v_cvt_pk_bf16_f32 v61, v34, v35
    v_pk_mul_f32 v[36:37], v[140:141], s[10:11]
    v_pk_mul_f32 v[38:39], v[142:143], s[10:11]
    v_exp_f32_e64 v36, v36 clamp
    v_exp_f32_e64 v37, v37 clamp
    v_exp_f32_e64 v38, v38 clamp
    v_exp_f32_e64 v39, v39 clamp
    v_max_f32 v32, 0, v140
    v_max_f32 v33, 0, v141
    v_max_f32 v34, 0, v142
    v_max_f32 v35, 0, v143
    v_pk_add_f32 v[32:33], v[32:33], v[36:37]
    v_pk_add_f32 v[34:35], v[34:35], v[38:39]
    v_pk_add_f32 v[32:33], v[32:33], s[12:13]
    v_pk_add_f32 v[34:35], v[34:35], s[12:13]
    v_cvt_pk_bf16_f32 v62, v32, v33
    v_cvt_pk_bf16_f32 v63, v34, v35
    v_and_b32 v62, v62, v2
    v_and_b32 v63, v63, v2
    s_add_u32 s52, s58, 3
    s_lshl_b32 s52, s52, 4
    s_add_u32 s52, s52, s55
    s_lshl_b32 s52, s52, 10
    s_add_u32 s52, s52, 7340032
    buffer_store_dwordx4 v[60:63], v9, s[20:23], s52 offen
    v_pk_mul_f32 v[36:37], v[144:145], s[10:11]
    v_pk_mul_f32 v[38:39], v[146:147], s[10:11]
    v_exp_f32_e64 v36, v36 clamp
    v_exp_f32_e64 v37, v37 clamp
    v_exp_f32_e64 v38, v38 clamp
    v_exp_f32_e64 v39, v39 clamp
    v_max_f32 v32, 0, v144
    v_max_f32 v33, 0, v145
    v_max_f32 v34, 0, v146
    v_max_f32 v35, 0, v147
    v_pk_add_f32 v[32:33], v[32:33], v[36:37]
    v_pk_add_f32 v[34:35], v[34:35], v[38:39]
    v_pk_add_f32 v[32:33], v[32:33], s[12:13]
    v_pk_add_f32 v[34:35], v[34:35], s[12:13]
    v_cvt_pk_bf16_f32 v64, v32, v33
    v_cvt_pk_bf16_f32 v65, v34, v35
    v_pk_mul_f32 v[36:37], v[148:149], s[10:11]
    v_pk_mul_f32 v[38:39], v[150:151], s[10:11]
    v_exp_f32_e64 v36, v36 clamp
    v_exp_f32_e64 v37, v37 clamp
    v_exp_f32_e64 v38, v38 clamp
    v_exp_f32_e64 v39, v39 clamp
    v_max_f32 v32, 0, v148
    v_max_f32 v33, 0, v149
    v_max_f32 v34, 0, v150
    v_max_f32 v35, 0, v151
    v_pk_add_f32 v[32:33], v[32:33], v[36:37]
    v_pk_add_f32 v[34:35], v[34:35], v[38:39]
    v_pk_add_f32 v[32:33], v[32:33], s[12:13]
    v_pk_add_f32 v[34:35], v[34:35], s[12:13]
    v_cvt_pk_bf16_f32 v66, v32, v33
    v_cvt_pk_bf16_f32 v67, v34, v35
    v_pk_mul_f32 v[36:37], v[152:153], s[10:11]
    v_pk_mul_f32 v[38:39], v[154:155], s[10:11]
    v_exp_f32_e64 v36, v36 clamp
    v_exp_f32_e64 v37, v37 clamp
    v_exp_f32_e64 v38, v38 clamp
    v_exp_f32_e64 v39, v39 clamp
    v_max_f32 v32, 0, v152
    v_max_f32 v33, 0, v153
    v_max_f32 v34, 0, v154
    v_max_f32 v35, 0, v155
    v_pk_add_f32 v[32:33], v[32:33], v[36:37]
    v_pk_add_f32 v[34:35], v[34:35], v[38:39]
    v_pk_add_f32 v[32:33], v[32:33], s[12:13]
    v_pk_add_f32 v[34:35], v[34:35], s[12:13]
    v_cvt_pk_bf16_f32 v68, v32, v33
    v_cvt_pk_bf16_f32 v69, v34, v35
    v_pk_mul_f32 v[36:37], v[156:157], s[10:11]
    v_pk_mul_f32 v[38:39], v[158:159], s[10:11]
    v_exp_f32_e64 v36, v36 clamp
    v_exp_f32_e64 v37, v37 clamp
    v_exp_f32_e64 v38, v38 clamp
    v_exp_f32_e64 v39, v39 clamp
    v_max_f32 v32, 0, v156
    v_max_f32 v33, 0, v157
    v_max_f32 v34, 0, v158
    v_max_f32 v35, 0, v159
    v_pk_add_f32 v[32:33], v[32:33], v[36:37]
    v_pk_add_f32 v[34:35], v[34:35], v[38:39]
    v_pk_add_f32 v[32:33], v[32:33], s[12:13]
    v_pk_add_f32 v[34:35], v[34:35], s[12:13]
    v_cvt_pk_bf16_f32 v70, v32, v33
    v_cvt_pk_bf16_f32 v71, v34, v35
    v_pk_mul_f32 v[36:37], v[160:161], s[10:11]
    v_pk_mul_f32 v[38:39], v[162:163], s[10:11]
    v_exp_f32_e64 v36, v36 clamp
    v_exp_f32_e64 v37, v37 clamp
    v_exp_f32_e64 v38, v38 clamp
    v_exp_f32_e64 v39, v39 clamp
    v_max_f32 v32, 0, v160
    v_max_f32 v33, 0, v161
    v_max_f32 v34, 0, v162
    v_max_f32 v35, 0, v163
    v_pk_add_f32 v[32:33], v[32:33], v[36:37]
    v_pk_add_f32 v[34:35], v[34:35], v[38:39]
    v_pk_add_f32 v[32:33], v[32:33], s[12:13]
    v_pk_add_f32 v[34:35], v[34:35], s[12:13]
    v_cvt_pk_bf16_f32 v72, v32, v33
    v_cvt_pk_bf16_f32 v73, v34, v35
    v_and_b32 v72, v72, v3
    v_and_b32 v73, v73, v3
    v_pk_mul_f32 v[36:37], v[164:165], s[10:11]
    v_pk_mul_f32 v[38:39], v[166:167], s[10:11]
    v_exp_f32_e64 v36, v36 clamp
    v_exp_f32_e64 v37, v37 clamp
    v_exp_f32_e64 v38, v38 clamp
    v_exp_f32_e64 v39, v39 clamp
    v_max_f32 v32, 0, v164
    v_max_f32 v33, 0, v165
    v_max_f32 v34, 0, v166
    v_max_f32 v35, 0, v167
    v_pk_add_f32 v[32:33], v[32:33], v[36:37]
    v_pk_add_f32 v[34:35], v[34:35], v[38:39]
    v_pk_add_f32 v[32:33], v[32:33], s[12:13]
    v_pk_add_f32 v[34:35], v[34:35], s[12:13]
    v_cvt_pk_bf16_f32 v74, v32, v33
    v_cvt_pk_bf16_f32 v75, v34, v35
    v_and_b32 v74, v74, v3
    v_and_b32 v75, v75, v3
    v_pk_mul_f32 v[36:37], v[168:169], s[10:11]
    v_pk_mul_f32 v[38:39], v[170:171], s[10:11]
    v_exp_f32_e64 v36, v36 clamp
    v_exp_f32_e64 v37, v37 clamp
    v_exp_f32_e64 v38, v38 clamp
    v_exp_f32_e64 v39, v39 clamp
    v_max_f32 v32, 0, v168
    v_max_f32 v33, 0, v169
    v_max_f32 v34, 0, v170
    v_max_f32 v35, 0, v171
    v_pk_add_f32 v[32:33], v[32:33], v[36:37]
    v_pk_add_f32 v[34:35], v[34:35], v[38:39]
    v_pk_add_f32 v[32:33], v[32:33], s[12:13]
    v_pk_add_f32 v[34:35], v[34:35], s[12:13]
    v_cvt_pk_bf16_f32 v76, v32, v33
    v_cvt_pk_bf16_f32 v77, v34, v35
    v_and_b32 v76, v76, v3
    v_and_b32 v77, v77, v3
    v_pk_mul_f32 v[36:37], v[172:173], s[10:11]
    v_pk_mul_f32 v[38:39], v[174:175], s[10:11]
    v_exp_f32_e64 v36, v36 clamp
    v_exp_f32_e64 v37, v37 clamp
    v_exp_f32_e64 v38, v38 clamp
    v_exp_f32_e64 v39, v39 clamp
    v_max_f32 v32, 0, v172
    v_max_f32 v33, 0, v173
    v_max_f32 v34, 0, v174
    v_max_f32 v35, 0, v175
    v_pk_add_f32 v[32:33], v[32:33], v[36:37]
    v_pk_add_f32 v[34:35], v[34:35], v[38:39]
    v_pk_add_f32 v[32:33], v[32:33], s[12:13]
    v_pk_add_f32 v[34:35], v[34:35], s[12:13]
    v_cvt_pk_bf16_f32 v78, v32, v33
    v_cvt_pk_bf16_f32 v79, v34, v35
    v_and_b32 v78, v78, v3
    v_and_b32 v79, v79, v3
    v_cvt_pk_bf16_f32 v80, v176, v177
    v_cvt_pk_bf16_f32 v81, v178, v179
    v_cvt_pk_bf16_f32 v82, v180, v181
    v_cvt_pk_bf16_f32 v83, v182, v183
    v_cvt_pk_bf16_f32 v84, v184, v185
    v_cvt_pk_bf16_f32 v85, v186, v187
    v_cvt_pk_bf16_f32 v86, v188, v189
    v_cvt_pk_bf16_f32 v87, v190, v191
    v_cvt_pk_bf16_f32 v88, v192, v193
    v_and_or_b32 v88, v88, v3, v4
    v_cvt_pk_bf16_f32 v89, v194, v195
    v_and_or_b32 v89, v89, v3, v4
    v_cvt_pk_bf16_f32 v90, v196, v197
    v_and_or_b32 v90, v90, v3, v4
    v_cvt_pk_bf16_f32 v91, v198, v199
    v_and_or_b32 v91, v91, v3, v4
    v_cvt_pk_bf16_f32 v92, v200, v201
    v_and_or_b32 v92, v92, v3, v4
    v_cvt_pk_bf16_f32 v93, v202, v203
    v_and_or_b32 v93, v93, v3, v4
    v_cvt_pk_bf16_f32 v94, v204, v205
    v_and_or_b32 v94, v94, v3, v4
    v_cvt_pk_bf16_f32 v95, v206, v207
    v_and_or_b32 v95, v95, v3, v4
    s_nop 1
    v_mfma_f32_16x16x32_bf16 v[96:99], v[64:67], v[80:83], 0
    v_mfma_f32_16x16x32_bf16 v[100:103], v[64:67], v[88:91], 0
    v_mfma_f32_16x16x32_bf16 v[104:107], v[72:75], v[80:83], 0
    v_mfma_f32_16x16x32_bf16 v[108:111], v[72:75], v[88:91], 0
    v_mfma_f32_16x16x32_bf16 v[96:99], v[68:71], v[84:87], v[96:99]
    v_mfma_f32_16x16x32_bf16 v[100:103], v[68:71], v[92:95], v[100:103]
    v_mfma_f32_16x16x32_bf16 v[104:107], v[76:79], v[84:87], v[104:107]
    v_mfma_f32_16x16x32_bf16 v[108:111], v[76:79], v[92:95], v[108:111]
    s_nop 9
    s_lshl_b32 s52, s55, 5
    s_lshl_b32 s53, s49, 1
    s_add_u32 s52, s52, s53
    s_add_u32 s52, s52, s51
    s_lshl_b32 s52, s52, 12
    s_add_u32 s52, s52, 9437184
    buffer_store_dwordx4 v[96:99], v9, s[20:23], s52 offen offset:0
    buffer_store_dwordx4 v[100:103], v9, s[20:23], s52 offen offset:1024
    buffer_store_dwordx4 v[104:107], v9, s[20:23], s52 offen offset:2048
    buffer_store_dwordx4 v[108:111], v9, s[20:23], s52 offen offset:3072
    s_branch K1_END
K1_DMAW:
    s_and_b32 s54, s50, 3
    v_lshrrev_b32 v24, 3, v1
    v_lshrrev_b32 v25, 4, v1
    v_and_b32 v25, 1, v25
    s_and_b32 s55, s54, 1
    s_lshl_b32 s55, s55, 1
    v_or_b32 v25, s55, v25
    v_lshrrev_b32 v26, 1, v1
    v_and_b32 v26, 3, v26
    v_xor_b32 v25, v25, v26
    v_and_b32 v26, 1, v1
    v_lshlrev_b32 v26, 4, v26
    s_lshl_b32 s55, s54, 3
    v_add_u32 v24, s55, v24
    v_lshl_add_u32 v27, v25, 5, v26
    v_lshrrev_b32 v25, 1, v25
    v_lshlrev_b32 v25, 3, v25
    v_sub_u32 v25, v27, v25
    v_mul_u32_u24 v26, 2688, v24
    v_add_u32 v25, v25, v26
    v_mul_u32_u24 v26, 3584, v24
    v_add_u32 v27, v27, v26
    s_mul_i32 s52, s56, 112
    s_mul_i32 s53, s56, 320
    s_add_u32 s53, s53, 1024
    s_cmp_eq_u32 s57, 0
    s_cselect_b64 vcc, -1, 0
    v_add_u32 v2, s52, v25
    v_add_u32 v2, 0, v2
    v_add_u32 v26, s53, v27
    v_cndmask_b32 v2, v26, v2, vcc
    v_add_u32 v3, s52, v25
    v_add_u32 v3, 896, v3
    v_add_u32 v26, s53, v27
    v_add_u32 v26, 128, v26
    v_cndmask_b32 v3, v26, v3, vcc
    v_add_u32 v4, s52, v25
    v_add_u32 v4, 1792, v4
    v_add_u32 v26, s53, v27
    v_cndmask_b32 v4, v26, v4, vcc
    s_lshl_b32 s52, s56, 7
    v_add_u32 v5, s52, v27
    v_add_u32 v26, s53, v27
    v_add_u32 v26, 128, v26
    v_cndmask_b32 v5, v26, v5, vcc
    v_add_u32 v6, s52, v27
    v_lshrrev_b32 v24, 2, v1
    s_and_b32 s55, s54, 1
    s_lshl_b32 s55, s55, 4
    v_add_u32 v24, s55, v24
    v_mul_u32_u24 v24, 3584, v24
    v_lshrrev_b32 v25, 1, v1
    v_lshrrev_b32 v26, 5, v1
    v_xor_b32 v25, v25, v26
    v_and_b32 v25, 1, v25
    v_lshl_add_u32 v24, v25, 5, v24
    v_and_b32 v25, 1, v1
    v_lshl_add_u32 v24, v25, 4, v24
    v_add_u32 v24, s53, v24
    v_add_u32 v24, 256, v24
    v_cndmask_b32 v6, v24, v6, vcc
    s_cmp_eq_u32 s57, 0
    s_mov_b32 s55, 86016
    s_cselect_b32 s4, s55, 114688
    s_mov_b32 s68, 0
    s_mov_b32 s69, 0
    s_mov_b32 s70, 0
    s_mov_b32 s71, 0
    s_mov_b32 s72, 0
    v_lshrrev_b32 v24, 3, v1
    v_lshrrev_b32 v25, 4, v1
    v_and_b32 v26, 7, v1
    v_xor_b32 v25, v25, v26
    v_mul_u32_u24 v24, 896, v24
    v_lshl_add_u32 v7, v25, 4, v24
    v_xor_b32 v8, 64, v7
    s_lshl_b32 s52, s49, 7
    s_lshl_b32 s53, s54, 5
    s_add_u32 s52, s52, s53
    s_mul_i32 s73, s52, 896
    s_lshl_b32 s5, s54, 10
    s_lshl_b32 s6, s54, 12
    s_add_u32 s6, s6, 81920
    s_and_b32 s52, s50, 2
    s_cmp_eq_u32 s57, 0
    s_cselect_b32 s55, 3, 1
    s_cselect_b32 s54, 1, 2
    s_lshl_b32 s8, s55, 12
    s_lshl_b32 s7, s54, 12
    s_add_u32 s53, s52, 0
    v_lshrrev_b32 v24, 4, v1
    v_lshrrev_b32 v25, 2, v1
    v_and_b32 v25, 3, v25
    v_and_b32 v26, 3, v1
    v_lshlrev_b32 v12, 3, v26
    v_and_b32 v26, 1, v24
    v_lshl_add_u32 v12, v24, 10, v12
    v_lshl_add_u32 v12, v25, 7, v12
    v_lshrrev_b32 v27, 1, v25
    v_lshl_or_b32 v27, v26, 1, v27
    v_xor_b32 v27, s53, v27
    v_lshl_add_u32 v12, v27, 5, v12
    v_add_u32 v12, s8, v12
    v_add_u32 v13, s7, v12
    s_add_u32 s53, s52, 1
    v_lshrrev_b32 v24, 4, v1
    v_lshrrev_b32 v25, 2, v1
    v_and_b32 v25, 3, v25
    v_and_b32 v26, 3, v1
    v_lshlrev_b32 v14, 3, v26
    v_and_b32 v26, 1, v24
    v_lshl_add_u32 v14, v24, 10, v14
    v_lshl_add_u32 v14, v25, 7, v14
    v_lshrrev_b32 v27, 1, v25
    v_lshl_or_b32 v27, v26, 1, v27
    v_xor_b32 v27, s53, v27
    v_lshl_add_u32 v14, v27, 5, v14
    v_add_u32 v14, s8, v14
    v_add_u32 v15, s7, v14
    v_add_u32 v18, 40960, v12
    v_add_u32 v19, 40960, v13
    v_add_u32 v20, 40960, v14
    v_add_u32 v21, 40960, v15
    s_setprio 1
    s_add_u32 m0, s6, 0
    s_add_u32 s52, s73, 0
    buffer_load_dwordx4 v7, s[16:19], s52 offen lds
    s_add_u32 m0, s6, 1024
    s_add_u32 s52, s73, 7168
    buffer_load_dwordx4 v8, s[16:19], s52 offen lds
    s_add_u32 m0, s6, 2048
    s_add_u32 s52, s73, 14336
    buffer_load_dwordx4 v7, s[16:19], s52 offen lds
    s_add_u32 m0, s6, 3072
    s_add_u32 s52, s73, 21504
    buffer_load_dwordx4 v8, s[16:19], s52 offen lds
    s_add_u32 m0, s5, 0
    s_nop 0
    buffer_load_dwordx4 v2, s[28:31], s68 offen lds
    s_add_u32 s68, s68, s4
    s_add_u32 m0, s5, 4096
    s_nop 0
    buffer_load_dwordx4 v3, s[32:35], s69 offen lds
    s_add_u32 s69, s69, s4
    s_add_u32 m0, s5, 8192
    s_nop 0
    buffer_load_dwordx4 v4, s[36:39], s70 offen lds
    s_add_u32 s70, s70, s4
    s_add_u32 m0, s5, 12288
    s_nop 0
    buffer_load_dwordx4 v5, s[40:43], s71 offen lds
    s_add_u32 s71, s71, 114688
    s_add_u32 m0, s5, 16384
    s_nop 0
    buffer_load_dwordx4 v6, s[44:47], s72 offen lds
    s_add_u32 s72, s72, 114688
    s_add_u32 m0, s5, 20480
    s_nop 0
    buffer_load_dwordx4 v2, s[28:31], s68 offen lds
    s_add_u32 s68, s68, s4
    s_add_u32 m0, s5, 24576
    s_nop 0
    buffer_load_dwordx4 v3, s[32:35], s69 offen lds
    s_add_u32 s69, s69, s4
    s_add_u32 m0, s5, 28672
    s_nop 0
    buffer_load_dwordx4 v4, s[36:39], s70 offen lds
    s_add_u32 s70, s70, s4
    s_add_u32 m0, s5, 32768
    s_nop 0
    buffer_load_dwordx4 v5, s[40:43], s71 offen lds
    s_add_u32 s71, s71, 114688
    s_add_u32 m0, s5, 36864
    s_nop 0
    buffer_load_dwordx4 v6, s[44:47], s72 offen lds
    s_add_u32 s72, s72, 114688
    s_add_u32 m0, s6, 16384
    s_add_u32 s52, s73, 128
    buffer_load_dwordx4 v7, s[16:19], s52 offen lds
    s_add_u32 m0, s6, 17408
    s_add_u32 s52, s73, 7296
    buffer_load_dwordx4 v8, s[16:19], s52 offen lds
    s_add_u32 m0, s6, 18432
    s_add_u32 s52, s73, 14464
    buffer_load_dwordx4 v7, s[16:19], s52 offen lds
    s_add_u32 m0, s6, 19456
    s_add_u32 s52, s73, 21632
    buffer_load_dwordx4 v8, s[16:19], s52 offen lds
    s_add_u32 m0, s5, 40960
    s_nop 0
    buffer_load_dwordx4 v2, s[28:31], s68 offen lds
    s_add_u32 s68, s68, s4
    s_add_u32 m0, s5, 45056
    s_nop 0
    buffer_load_dwordx4 v3, s[32:35], s69 offen lds
    s_add_u32 s69, s69, s4
    s_add_u32 m0, s5, 49152
    s_nop 0
    buffer_load_dwordx4 v4, s[36:39], s70 offen lds
    s_add_u32 s70, s70, s4
    s_add_u32 m0, s5, 53248
    s_nop 0
    buffer_load_dwordx4 v5, s[40:43], s71 offen lds
    s_add_u32 s71, s71, 114688
    s_add_u32 m0, s5, 57344
    s_nop 0
    buffer_load_dwordx4 v6, s[44:47], s72 offen lds
    s_add_u32 s72, s72, 114688
    s_waitcnt vmcnt(23)
    v_mov_b32 v11, 0
    v_lshlrev_b32 v24, 16, v96
    v_and_b32 v25, s60, v96
    v_lshlrev_b32 v26, 16, v100
    v_and_b32 v27, s60, v100
    v_pk_mul_f32 v[24:25], v[24:25], v[26:27]
    v_cvt_pk_bf16_f32 v28, v24, v25
    v_lshlrev_b32 v24, 16, v28
    v_and_b32 v25, s60, v28
    v_add_f32 v11, v11, v24
    v_add_f32 v11, v11, v25
    v_lshlrev_b32 v24, 16, v97
    v_and_b32 v25, s60, v97
    v_lshlrev_b32 v26, 16, v101
    v_and_b32 v27, s60, v101
    v_pk_mul_f32 v[24:25], v[24:25], v[26:27]
    v_cvt_pk_bf16_f32 v28, v24, v25
    v_lshlrev_b32 v24, 16, v28
    v_and_b32 v25, s60, v28
    v_add_f32 v11, v11, v24
    v_add_f32 v11, v11, v25
    v_lshlrev_b32 v24, 16, v98
    v_and_b32 v25, s60, v98
    v_lshlrev_b32 v26, 16, v102
    v_and_b32 v27, s60, v102
    v_pk_mul_f32 v[24:25], v[24:25], v[26:27]
    v_cvt_pk_bf16_f32 v28, v24, v25
    v_lshlrev_b32 v24, 16, v28
    v_and_b32 v25, s60, v28
    v_add_f32 v11, v11, v24
    v_add_f32 v11, v11, v25
    v_lshlrev_b32 v24, 16, v99
    v_and_b32 v25, s60, v99
    v_lshlrev_b32 v26, 16, v103
    v_and_b32 v27, s60, v103
    v_pk_mul_f32 v[24:25], v[24:25], v[26:27]
    v_cvt_pk_bf16_f32 v28, v24, v25
    v_lshlrev_b32 v24, 16, v28
    v_and_b32 v25, s60, v28
    v_add_f32 v11, v11, v24
    v_add_f32 v11, v11, v25
    s_nop 1
    v_add_f32_dpp v11, v11, v11 quad_perm:[1,0,3,2] row_mask:0xf bank_mask:0xf
    s_nop 1
    v_add_f32_dpp v11, v11, v11 quad_perm:[2,3,0,1] row_mask:0xf bank_mask:0xf
    s_nop 1
    v_add_f32_dpp v11, v11, v11 row_half_mirror row_mask:0xf bank_mask:0xf
    s_nop 1
    v_add_f32_dpp v11, v11, v11 row_mirror row_mask:0xf bank_mask:0xf
    s_nop 1
    v_readlane_b32 s52, v11, 16
    v_readlane_b32 s53, v11, 32
    v_readlane_b32 s54, v11, 48
    s_nop 1
    v_add_f32 v11, s52, v11
    v_add_f32 v11, s53, v11
    v_add_f32 v11, s54, v11
    v_cvt_pk_bf16_f32 v11, v11, v11
    v_lshlrev_b32 v11, 16, v11
    v_mul_f32 v11, s62, v11
    v_exp_f32 v11, v11
    s_nop 0
    v_add_f32 v11, 1.0, v11
    v_rcp_f32 v11, v11
    s_nop 0
    v_cvt_pk_bf16_f32 v11, v11, v11
    v_lshlrev_b32 v11, 16, v11
    s_waitcnt vmcnt(14)
    s_barrier
    ds_read_b128 v[32:35], v9 offset:0
    ds_read_b128 v[36:39], v9 offset:2048
    ds_read_b128 v[40:43], v9 offset:4096
    ds_read_b128 v[44:47], v9 offset:6144
    ds_read_b64_tr_b16 v[64:65], v12 offset:0
    ds_read_b64_tr_b16 v[66:67], v12 offset:512
    ds_read_b64_tr_b16 v[68:69], v13 offset:0
    ds_read_b64_tr_b16 v[70:71], v13 offset:512
    ds_read_b64_tr_b16 v[72:73], v14 offset:0
    ds_read_b64_tr_b16 v[74:75], v14 offset:512
    ds_read_b64_tr_b16 v[76:77], v15 offset:0
    ds_read_b64_tr_b16 v[78:79], v15 offset:512
    s_waitcnt vmcnt(9) lgkmcnt(0)
    s_barrier
    s_add_u32 m0, s5, 61440
    s_nop 0
    buffer_load_dwordx4 v2, s[28:31], s68 offen lds
    s_add_u32 s68, s68, s4
    s_add_u32 m0, s5, 65536
    s_nop 0
    buffer_load_dwordx4 v3, s[32:35], s69 offen lds
    s_add_u32 s69, s69, s4
    s_add_u32 m0, s5, 69632
    s_nop 0
    buffer_load_dwordx4 v4, s[36:39], s70 offen lds
    s_add_u32 s70, s70, s4
    s_add_u32 m0, s5, 73728
    s_nop 0
    buffer_load_dwordx4 v5, s[40:43], s71 offen lds
    s_add_u32 s71, s71, 114688
    s_add_u32 m0, s5, 77824
    s_nop 0
    buffer_load_dwordx4 v6, s[44:47], s72 offen lds
    s_add_u32 s72, s72, 114688
    v_mfma_f32_16x16x32_bf16 v[112:115], v[64:67], v[32:35], 0
    ds_read_b128 v[48:51], v10 offset:0
    v_mfma_f32_16x16x32_bf16 v[116:119], v[64:67], v[36:39], 0
    ds_read_b128 v[52:55], v10 offset:2048
    v_mfma_f32_16x16x32_bf16 v[120:123], v[64:67], v[40:43], 0
    ds_read_b128 v[56:59], v10 offset:4096
    v_mfma_f32_16x16x32_bf16 v[124:127], v[64:67], v[44:47], 0
    ds_read_b128 v[60:63], v10 offset:6144
    v_mfma_f32_16x16x32_bf16 v[128:131], v[68:71], v[32:35], 0
    ds_read_b64_tr_b16 v[88:89], v12 offset:20480
    v_mfma_f32_16x16x32_bf16 v[132:135], v[68:71], v[36:39], 0
    ds_read_b64_tr_b16 v[90:91], v12 offset:20992
    v_mfma_f32_16x16x32_bf16 v[136:139], v[68:71], v[40:43], 0
    ds_read_b64_tr_b16 v[92:93], v13 offset:20480
    v_mfma_f32_16x16x32_bf16 v[140:143], v[68:71], v[44:47], 0
    ds_read_b64_tr_b16 v[94:95], v13 offset:20992
    v_mfma_f32_16x16x32_bf16 v[144:147], v[72:75], v[32:35], 0
    ds_read_b64_tr_b16 v[96:97], v14 offset:20480
    v_mfma_f32_16x16x32_bf16 v[148:151], v[72:75], v[36:39], 0
    ds_read_b64_tr_b16 v[98:99], v14 offset:20992
    v_mfma_f32_16x16x32_bf16 v[152:155], v[72:75], v[40:43], 0
    ds_read_b64_tr_b16 v[100:101], v15 offset:20480
    v_mfma_f32_16x16x32_bf16 v[156:159], v[72:75], v[44:47], 0
    ds_read_b64_tr_b16 v[102:103], v15 offset:20992
    v_mfma_f32_16x16x32_bf16 v[160:163], v[76:79], v[32:35], 0
    v_mfma_f32_16x16x32_bf16 v[164:167], v[76:79], v[36:39], 0
    v_mfma_f32_16x16x32_bf16 v[168:171], v[76:79], v[40:43], 0
    v_mfma_f32_16x16x32_bf16 v[172:175], v[76:79], v[44:47], 0
    s_waitcnt vmcnt(5) lgkmcnt(0)
    s_barrier
    s_add_u32 m0, s5, 0
    s_nop 0
    buffer_load_dwordx4 v2, s[28:31], s68 offen lds
    s_add_u32 s68, s68, s4
    s_add_u32 m0, s5, 4096
    s_nop 0
    buffer_load_dwordx4 v3, s[32:35], s69 offen lds
    s_add_u32 s69, s69, s4
    s_add_u32 m0, s5, 8192
    s_nop 0
    buffer_load_dwordx4 v4, s[36:39], s70 offen lds
    s_add_u32 s70, s70, s4
    s_add_u32 m0, s5, 12288
    s_nop 0
    buffer_load_dwordx4 v5, s[40:43], s71 offen lds
    s_add_u32 s71, s71, 114688
    s_add_u32 m0, s5, 16384
    s_nop 0
    buffer_load_dwordx4 v6, s[44:47], s72 offen lds
    s_add_u32 s72, s72, 114688
    s_add_u32 m0, s6, 0
    s_add_u32 s52, s73, 256
    buffer_load_dwordx4 v7, s[16:19], s52 offen lds
    s_add_u32 m0, s6, 1024
    s_add_u32 s52, s73, 7424
    buffer_load_dwordx4 v8, s[16:19], s52 offen lds
    s_add_u32 m0, s6, 2048
    s_add_u32 s52, s73, 14592
    buffer_load_dwordx4 v7, s[16:19], s52 offen lds
    s_add_u32 m0, s6, 3072
    s_add_u32 s52, s73, 21760
    buffer_load_dwordx4 v8, s[16:19], s52 offen lds
    v_mfma_f32_16x16x32_bf16 v[112:115], v[88:91], v[48:51], v[112:115]
    ds_read_b128 v[32:35], v9 offset:16384
    v_mfma_f32_16x16x32_bf16 v[116:119], v[88:91], v[52:55], v[116:119]
    ds_read_b128 v[36:39], v9 offset:18432
    v_mfma_f32_16x16x32_bf16 v[120:123], v[88:91], v[56:59], v[120:123]
    ds_read_b128 v[40:43], v9 offset:20480
    v_mfma_f32_16x16x32_bf16 v[124:127], v[88:91], v[60:63], v[124:127]
    ds_read_b128 v[44:47], v9 offset:22528
    v_mfma_f32_16x16x32_bf16 v[128:131], v[92:95], v[48:51], v[128:131]
    ds_read_b64_tr_b16 v[64:65], v18 offset:0
    v_mfma_f32_16x16x32_bf16 v[132:135], v[92:95], v[52:55], v[132:135]
    ds_read_b64_tr_b16 v[66:67], v18 offset:512
    v_mfma_f32_16x16x32_bf16 v[136:139], v[92:95], v[56:59], v[136:139]
    ds_read_b64_tr_b16 v[68:69], v19 offset:0
    v_mfma_f32_16x16x32_bf16 v[140:143], v[92:95], v[60:63], v[140:143]
    ds_read_b64_tr_b16 v[70:71], v19 offset:512
    v_mfma_f32_16x16x32_bf16 v[144:147], v[96:99], v[48:51], v[144:147]
    ds_read_b64_tr_b16 v[72:73], v20 offset:0
    v_mfma_f32_16x16x32_bf16 v[148:151], v[96:99], v[52:55], v[148:151]
    ds_read_b64_tr_b16 v[74:75], v20 offset:512
    v_mfma_f32_16x16x32_bf16 v[152:155], v[96:99], v[56:59], v[152:155]
    ds_read_b64_tr_b16 v[76:77], v21 offset:0
    v_mfma_f32_16x16x32_bf16 v[156:159], v[96:99], v[60:63], v[156:159]
    ds_read_b64_tr_b16 v[78:79], v21 offset:512
    v_mfma_f32_16x16x32_bf16 v[160:163], v[100:103], v[48:51], v[160:163]
    v_mfma_f32_16x16x32_bf16 v[164:167], v[100:103], v[52:55], v[164:167]
    v_mfma_f32_16x16x32_bf16 v[168:171], v[100:103], v[56:59], v[168:171]
    v_mfma_f32_16x16x32_bf16 v[172:175], v[100:103], v[60:63], v[172:175]
    s_waitcnt vmcnt(9) lgkmcnt(0)
    s_barrier
    s_add_u32 m0, s5, 20480
    s_nop 0
    buffer_load_dwordx4 v2, s[28:31], s68 offen lds
    s_add_u32 s68, s68, s4
    s_add_u32 m0, s5, 24576
    s_nop 0
    buffer_load_dwordx4 v3, s[32:35], s69 offen lds
    s_add_u32 s69, s69, s4
    s_add_u32 m0, s5, 28672
    s_nop 0
    buffer_load_dwordx4 v4, s[36:39], s70 offen lds
    s_add_u32 s70, s70, s4
    s_add_u32 m0, s5, 32768
    s_nop 0
    buffer_load_dwordx4 v5, s[40:43], s71 offen lds
    s_add_u32 s71, s71, 114688
    s_add_u32 m0, s5, 36864
    s_nop 0
    buffer_load_dwordx4 v6, s[44:47], s72 offen lds
    s_add_u32 s72, s72, 114688
    v_mfma_f32_16x16x32_bf16 v[112:115], v[64:67], v[32:35], v[112:115]
    ds_read_b128 v[48:51], v10 offset:16384
    v_mfma_f32_16x16x32_bf16 v[116:119], v[64:67], v[36:39], v[116:119]
    ds_read_b128 v[52:55], v10 offset:18432
    v_mfma_f32_16x16x32_bf16 v[120:123], v[64:67], v[40:43], v[120:123]
    ds_read_b128 v[56:59], v10 offset:20480
    v_mfma_f32_16x16x32_bf16 v[124:127], v[64:67], v[44:47], v[124:127]
    ds_read_b128 v[60:63], v10 offset:22528
    v_mfma_f32_16x16x32_bf16 v[128:131], v[68:71], v[32:35], v[128:131]
    ds_read_b64_tr_b16 v[88:89], v18 offset:20480
    v_mfma_f32_16x16x32_bf16 v[132:135], v[68:71], v[36:39], v[132:135]
    ds_read_b64_tr_b16 v[90:91], v18 offset:20992
    v_mfma_f32_16x16x32_bf16 v[136:139], v[68:71], v[40:43], v[136:139]
    ds_read_b64_tr_b16 v[92:93], v19 offset:20480
    v_mfma_f32_16x16x32_bf16 v[140:143], v[68:71], v[44:47], v[140:143]
    ds_read_b64_tr_b16 v[94:95], v19 offset:20992
    v_mfma_f32_16x16x32_bf16 v[144:147], v[72:75], v[32:35], v[144:147]
    ds_read_b64_tr_b16 v[96:97], v20 offset:20480
    v_mfma_f32_16x16x32_bf16 v[148:151], v[72:75], v[36:39], v[148:151]
    ds_read_b64_tr_b16 v[98:99], v20 offset:20992
    v_mfma_f32_16x16x32_bf16 v[152:155], v[72:75], v[40:43], v[152:155]
    ds_read_b64_tr_b16 v[100:101], v21 offset:20480
    v_mfma_f32_16x16x32_bf16 v[156:159], v[72:75], v[44:47], v[156:159]
    ds_read_b64_tr_b16 v[102:103], v21 offset:20992
    v_mfma_f32_16x16x32_bf16 v[160:163], v[76:79], v[32:35], v[160:163]
    v_mfma_f32_16x16x32_bf16 v[164:167], v[76:79], v[36:39], v[164:167]
    v_mfma_f32_16x16x32_bf16 v[168:171], v[76:79], v[40:43], v[168:171]
    v_mfma_f32_16x16x32_bf16 v[172:175], v[76:79], v[44:47], v[172:175]
    s_waitcnt vmcnt(5) lgkmcnt(0)
    s_barrier
    s_add_u32 m0, s5, 40960
    s_nop 0
    buffer_load_dwordx4 v2, s[28:31], s68 offen lds
    s_add_u32 s68, s68, s4
    s_add_u32 m0, s5, 45056
    s_nop 0
    buffer_load_dwordx4 v3, s[32:35], s69 offen lds
    s_add_u32 s69, s69, s4
    s_add_u32 m0, s5, 49152
    s_nop 0
    buffer_load_dwordx4 v4, s[36:39], s70 offen lds
    s_add_u32 s70, s70, s4
    s_add_u32 m0, s5, 53248
    s_nop 0
    buffer_load_dwordx4 v5, s[40:43], s71 offen lds
    s_add_u32 s71, s71, 114688
    s_add_u32 m0, s5, 57344
    s_nop 0
    buffer_load_dwordx4 v6, s[44:47], s72 offen lds
    s_add_u32 s72, s72, 114688
    s_add_u32 m0, s6, 16384
    s_add_u32 s52, s73, 384
    buffer_load_dwordx4 v7, s[16:19], s52 offen lds
    s_add_u32 m0, s6, 17408
    s_add_u32 s52, s73, 7552
    buffer_load_dwordx4 v8, s[16:19], s52 offen lds
    s_add_u32 m0, s6, 18432
    s_add_u32 s52, s73, 14720
    buffer_load_dwordx4 v7, s[16:19], s52 offen lds
    s_add_u32 m0, s6, 19456
    s_add_u32 s52, s73, 21888
    buffer_load_dwordx4 v8, s[16:19], s52 offen lds
    v_mfma_f32_16x16x32_bf16 v[112:115], v[88:91], v[48:51], v[112:115]
    ds_read_b128 v[32:35], v9 offset:0
    v_mfma_f32_16x16x32_bf16 v[116:119], v[88:91], v[52:55], v[116:119]
    ds_read_b128 v[36:39], v9 offset:2048
    v_mfma_f32_16x16x32_bf16 v[120:123], v[88:91], v[56:59], v[120:123]
    ds_read_b128 v[40:43], v9 offset:4096
    v_mfma_f32_16x16x32_bf16 v[124:127], v[88:91], v[60:63], v[124:127]
    ds_read_b128 v[44:47], v9 offset:6144
    v_mfma_f32_16x16x32_bf16 v[128:131], v[92:95], v[48:51], v[128:131]
    ds_read_b64_tr_b16 v[64:65], v12 offset:0
    v_mfma_f32_16x16x32_bf16 v[132:135], v[92:95], v[52:55], v[132:135]
    ds_read_b64_tr_b16 v[66:67], v12 offset:512
    v_mfma_f32_16x16x32_bf16 v[136:139], v[92:95], v[56:59], v[136:139]
    ds_read_b64_tr_b16 v[68:69], v13 offset:0
    v_mfma_f32_16x16x32_bf16 v[140:143], v[92:95], v[60:63], v[140:143]
    ds_read_b64_tr_b16 v[70:71], v13 offset:512
    v_mfma_f32_16x16x32_bf16 v[144:147], v[96:99], v[48:51], v[144:147]
    ds_read_b64_tr_b16 v[72:73], v14 offset:0
    v_mfma_f32_16x16x32_bf16 v[148:151], v[96:99], v[52:55], v[148:151]
    ds_read_b64_tr_b16 v[74:75], v14 offset:512
    v_mfma_f32_16x16x32_bf16 v[152:155], v[96:99], v[56:59], v[152:155]
    ds_read_b64_tr_b16 v[76:77], v15 offset:0
    v_mfma_f32_16x16x32_bf16 v[156:159], v[96:99], v[60:63], v[156:159]
    ds_read_b64_tr_b16 v[78:79], v15 offset:512
    v_mfma_f32_16x16x32_bf16 v[160:163], v[100:103], v[48:51], v[160:163]
    v_mfma_f32_16x16x32_bf16 v[164:167], v[100:103], v[52:55], v[164:167]
    v_mfma_f32_16x16x32_bf16 v[168:171], v[100:103], v[56:59], v[168:171]
    v_mfma_f32_16x16x32_bf16 v[172:175], v[100:103], v[60:63], v[172:175]
    s_waitcnt vmcnt(9) lgkmcnt(0)
    s_barrier
    s_add_u32 m0, s5, 61440
    s_nop 0
    buffer_load_dwordx4 v2, s[28:31], s68 offen lds
    s_add_u32 s68, s68, s4
    s_add_u32 m0, s5, 65536
    s_nop 0
    buffer_load_dwordx4 v3, s[32:35], s69 offen lds
    s_add_u32 s69, s69, s4
    s_add_u32 m0, s5, 69632
    s_nop 0
    buffer_load_dwordx4 v4, s[36:39], s70 offen lds
    s_add_u32 s70, s70, s4
    s_add_u32 m0, s5, 73728
    s_nop 0
    buffer_load_dwordx4 v5, s[40:43], s71 offen lds
    s_add_u32 s71, s71, 114688
    s_add_u32 m0, s5, 77824
    s_nop 0
    buffer_load_dwordx4 v6, s[44:47], s72 offen lds
    s_add_u32 s72, s72, 114688
    v_mfma_f32_16x16x32_bf16 v[112:115], v[64:67], v[32:35], v[112:115]
    ds_read_b128 v[48:51], v10 offset:0
    v_mfma_f32_16x16x32_bf16 v[116:119], v[64:67], v[36:39], v[116:119]
    ds_read_b128 v[52:55], v10 offset:2048
    v_mfma_f32_16x16x32_bf16 v[120:123], v[64:67], v[40:43], v[120:123]
    ds_read_b128 v[56:59], v10 offset:4096
    v_mfma_f32_16x16x32_bf16 v[124:127], v[64:67], v[44:47], v[124:127]
    ds_read_b128 v[60:63], v10 offset:6144
    v_mfma_f32_16x16x32_bf16 v[128:131], v[68:71], v[32:35], v[128:131]
    ds_read_b64_tr_b16 v[88:89], v12 offset:20480
    v_mfma_f32_16x16x32_bf16 v[132:135], v[68:71], v[36:39], v[132:135]
    ds_read_b64_tr_b16 v[90:91], v12 offset:20992
    v_mfma_f32_16x16x32_bf16 v[136:139], v[68:71], v[40:43], v[136:139]
    ds_read_b64_tr_b16 v[92:93], v13 offset:20480
    v_mfma_f32_16x16x32_bf16 v[140:143], v[68:71], v[44:47], v[140:143]
    ds_read_b64_tr_b16 v[94:95], v13 offset:20992
    v_mfma_f32_16x16x32_bf16 v[144:147], v[72:75], v[32:35], v[144:147]
    ds_read_b64_tr_b16 v[96:97], v14 offset:20480
    v_mfma_f32_16x16x32_bf16 v[148:151], v[72:75], v[36:39], v[148:151]
    ds_read_b64_tr_b16 v[98:99], v14 offset:20992
    v_mfma_f32_16x16x32_bf16 v[152:155], v[72:75], v[40:43], v[152:155]
    ds_read_b64_tr_b16 v[100:101], v15 offset:20480
    v_mfma_f32_16x16x32_bf16 v[156:159], v[72:75], v[44:47], v[156:159]
    ds_read_b64_tr_b16 v[102:103], v15 offset:20992
    v_mfma_f32_16x16x32_bf16 v[160:163], v[76:79], v[32:35], v[160:163]
    v_mfma_f32_16x16x32_bf16 v[164:167], v[76:79], v[36:39], v[164:167]
    v_mfma_f32_16x16x32_bf16 v[168:171], v[76:79], v[40:43], v[168:171]
    v_mfma_f32_16x16x32_bf16 v[172:175], v[76:79], v[44:47], v[172:175]
    s_waitcnt vmcnt(5) lgkmcnt(0)
    s_barrier
    s_add_u32 m0, s5, 0
    s_nop 0
    buffer_load_dwordx4 v2, s[28:31], s68 offen lds
    s_add_u32 s68, s68, s4
    s_add_u32 m0, s5, 4096
    s_nop 0
    buffer_load_dwordx4 v3, s[32:35], s69 offen lds
    s_add_u32 s69, s69, s4
    s_add_u32 m0, s5, 8192
    s_nop 0
    buffer_load_dwordx4 v4, s[36:39], s70 offen lds
    s_add_u32 s70, s70, s4
    s_add_u32 m0, s5, 12288
    s_nop 0
    buffer_load_dwordx4 v5, s[40:43], s71 offen lds
    s_add_u32 s71, s71, 114688
    s_add_u32 m0, s5, 16384
    s_nop 0
    buffer_load_dwordx4 v6, s[44:47], s72 offen lds
    s_add_u32 s72, s72, 114688
    s_add_u32 m0, s6, 0
    s_add_u32 s52, s73, 512
    buffer_load_dwordx4 v7, s[16:19], s52 offen lds
    s_add_u32 m0, s6, 1024
    s_add_u32 s52, s73, 7680
    buffer_load_dwordx4 v8, s[16:19], s52 offen lds
    s_add_u32 m0, s6, 2048
    s_add_u32 s52, s73, 14848
    buffer_load_dwordx4 v7, s[16:19], s52 offen lds
    s_add_u32 m0, s6, 3072
    s_add_u32 s52, s73, 22016
    buffer_load_dwordx4 v8, s[16:19], s52 offen lds
    v_mfma_f32_16x16x32_bf16 v[112:115], v[88:91], v[48:51], v[112:115]
    ds_read_b128 v[32:35], v9 offset:16384
    v_mfma_f32_16x16x32_bf16 v[116:119], v[88:91], v[52:55], v[116:119]
    ds_read_b128 v[36:39], v9 offset:18432
    v_mfma_f32_16x16x32_bf16 v[120:123], v[88:91], v[56:59], v[120:123]
    ds_read_b128 v[40:43], v9 offset:20480
    v_mfma_f32_16x16x32_bf16 v[124:127], v[88:91], v[60:63], v[124:127]
    ds_read_b128 v[44:47], v9 offset:22528
    v_mfma_f32_16x16x32_bf16 v[128:131], v[92:95], v[48:51], v[128:131]
    ds_read_b64_tr_b16 v[64:65], v18 offset:0
    v_mfma_f32_16x16x32_bf16 v[132:135], v[92:95], v[52:55], v[132:135]
    ds_read_b64_tr_b16 v[66:67], v18 offset:512
    v_mfma_f32_16x16x32_bf16 v[136:139], v[92:95], v[56:59], v[136:139]
    ds_read_b64_tr_b16 v[68:69], v19 offset:0
    v_mfma_f32_16x16x32_bf16 v[140:143], v[92:95], v[60:63], v[140:143]
    ds_read_b64_tr_b16 v[70:71], v19 offset:512
    v_mfma_f32_16x16x32_bf16 v[144:147], v[96:99], v[48:51], v[144:147]
    ds_read_b64_tr_b16 v[72:73], v20 offset:0
    v_mfma_f32_16x16x32_bf16 v[148:151], v[96:99], v[52:55], v[148:151]
    ds_read_b64_tr_b16 v[74:75], v20 offset:512
    v_mfma_f32_16x16x32_bf16 v[152:155], v[96:99], v[56:59], v[152:155]
    ds_read_b64_tr_b16 v[76:77], v21 offset:0
    v_mfma_f32_16x16x32_bf16 v[156:159], v[96:99], v[60:63], v[156:159]
    ds_read_b64_tr_b16 v[78:79], v21 offset:512
    v_mfma_f32_16x16x32_bf16 v[160:163], v[100:103], v[48:51], v[160:163]
    v_mfma_f32_16x16x32_bf16 v[164:167], v[100:103], v[52:55], v[164:167]
    v_mfma_f32_16x16x32_bf16 v[168:171], v[100:103], v[56:59], v[168:171]
    v_mfma_f32_16x16x32_bf16 v[172:175], v[100:103], v[60:63], v[172:175]
    s_waitcnt vmcnt(9) lgkmcnt(0)
    s_barrier
    s_add_u32 m0, s5, 20480
    s_nop 0
    buffer_load_dwordx4 v2, s[28:31], s68 offen lds
    s_add_u32 s68, s68, s4
    s_add_u32 m0, s5, 24576
    s_nop 0
    buffer_load_dwordx4 v3, s[32:35], s69 offen lds
    s_add_u32 s69, s69, s4
    s_add_u32 m0, s5, 28672
    s_nop 0
    buffer_load_dwordx4 v4, s[36:39], s70 offen lds
    s_add_u32 s70, s70, s4
    s_add_u32 m0, s5, 32768
    s_nop 0
    buffer_load_dwordx4 v5, s[40:43], s71 offen lds
    s_add_u32 s71, s71, 114688
    s_add_u32 m0, s5, 36864
    s_nop 0
    buffer_load_dwordx4 v6, s[44:47], s72 offen lds
    s_add_u32 s72, s72, 114688
    v_mfma_f32_16x16x32_bf16 v[112:115], v[64:67], v[32:35], v[112:115]
    ds_read_b128 v[48:51], v10 offset:16384
    v_mfma_f32_16x16x32_bf16 v[116:119], v[64:67], v[36:39], v[116:119]
    ds_read_b128 v[52:55], v10 offset:18432
    v_mfma_f32_16x16x32_bf16 v[120:123], v[64:67], v[40:43], v[120:123]
    ds_read_b128 v[56:59], v10 offset:20480
    v_mfma_f32_16x16x32_bf16 v[124:127], v[64:67], v[44:47], v[124:127]
    ds_read_b128 v[60:63], v10 offset:22528
    v_mfma_f32_16x16x32_bf16 v[128:131], v[68:71], v[32:35], v[128:131]
    ds_read_b64_tr_b16 v[88:89], v18 offset:20480
    v_mfma_f32_16x16x32_bf16 v[132:135], v[68:71], v[36:39], v[132:135]
    ds_read_b64_tr_b16 v[90:91], v18 offset:20992
    v_mfma_f32_16x16x32_bf16 v[136:139], v[68:71], v[40:43], v[136:139]
    ds_read_b64_tr_b16 v[92:93], v19 offset:20480
    v_mfma_f32_16x16x32_bf16 v[140:143], v[68:71], v[44:47], v[140:143]
    ds_read_b64_tr_b16 v[94:95], v19 offset:20992
    v_mfma_f32_16x16x32_bf16 v[144:147], v[72:75], v[32:35], v[144:147]
    ds_read_b64_tr_b16 v[96:97], v20 offset:20480
    v_mfma_f32_16x16x32_bf16 v[148:151], v[72:75], v[36:39], v[148:151]
    ds_read_b64_tr_b16 v[98:99], v20 offset:20992
    v_mfma_f32_16x16x32_bf16 v[152:155], v[72:75], v[40:43], v[152:155]
    ds_read_b64_tr_b16 v[100:101], v21 offset:20480
    v_mfma_f32_16x16x32_bf16 v[156:159], v[72:75], v[44:47], v[156:159]
    ds_read_b64_tr_b16 v[102:103], v21 offset:20992
    v_mfma_f32_16x16x32_bf16 v[160:163], v[76:79], v[32:35], v[160:163]
    v_mfma_f32_16x16x32_bf16 v[164:167], v[76:79], v[36:39], v[164:167]
    v_mfma_f32_16x16x32_bf16 v[168:171], v[76:79], v[40:43], v[168:171]
    v_mfma_f32_16x16x32_bf16 v[172:175], v[76:79], v[44:47], v[172:175]
    s_waitcnt vmcnt(5) lgkmcnt(0)
    s_barrier
    s_add_u32 m0, s5, 40960
    s_nop 0
    buffer_load_dwordx4 v2, s[28:31], s68 offen lds
    s_add_u32 s68, s68, s4
    s_add_u32 m0, s5, 45056
    s_nop 0
    buffer_load_dwordx4 v3, s[32:35], s69 offen lds
    s_add_u32 s69, s69, s4
    s_add_u32 m0, s5, 49152
    s_nop 0
    buffer_load_dwordx4 v4, s[36:39], s70 offen lds
    s_add_u32 s70, s70, s4
    s_add_u32 m0, s5, 53248
    s_nop 0
    buffer_load_dwordx4 v5, s[40:43], s71 offen lds
    s_add_u32 s71, s71, 114688
    s_add_u32 m0, s5, 57344
    s_nop 0
    buffer_load_dwordx4 v6, s[44:47], s72 offen lds
    s_add_u32 s72, s72, 114688
    s_add_u32 m0, s6, 16384
    s_add_u32 s52, s73, 640
    buffer_load_dwordx4 v7, s[16:19], s52 offen lds
    s_add_u32 m0, s6, 17408
    s_add_u32 s52, s73, 7808
    buffer_load_dwordx4 v8, s[16:19], s52 offen lds
    s_add_u32 m0, s6, 18432
    s_add_u32 s52, s73, 14976
    buffer_load_dwordx4 v7, s[16:19], s52 offen lds
    s_add_u32 m0, s6, 19456
    s_add_u32 s52, s73, 22144
    buffer_load_dwordx4 v8, s[16:19], s52 offen lds
    v_mfma_f32_16x16x32_bf16 v[112:115], v[88:91], v[48:51], v[112:115]
    ds_read_b128 v[32:35], v9 offset:0
    v_mfma_f32_16x16x32_bf16 v[116:119], v[88:91], v[52:55], v[116:119]
    ds_read_b128 v[36:39], v9 offset:2048
    v_mfma_f32_16x16x32_bf16 v[120:123], v[88:91], v[56:59], v[120:123]
    ds_read_b128 v[40:43], v9 offset:4096
    v_mfma_f32_16x16x32_bf16 v[124:127], v[88:91], v[60:63], v[124:127]
    ds_read_b128 v[44:47], v9 offset:6144
    v_mfma_f32_16x16x32_bf16 v[128:131], v[92:95], v[48:51], v[128:131]
    ds_read_b64_tr_b16 v[64:65], v12 offset:0
    v_mfma_f32_16x16x32_bf16 v[132:135], v[92:95], v[52:55], v[132:135]
    ds_read_b64_tr_b16 v[66:67], v12 offset:512
    v_mfma_f32_16x16x32_bf16 v[136:139], v[92:95], v[56:59], v[136:139]
    ds_read_b64_tr_b16 v[68:69], v13 offset:0
    v_mfma_f32_16x16x32_bf16 v[140:143], v[92:95], v[60:63], v[140:143]
    ds_read_b64_tr_b16 v[70:71], v13 offset:512
    v_mfma_f32_16x16x32_bf16 v[144:147], v[96:99], v[48:51], v[144:147]
    ds_read_b64_tr_b16 v[72:73], v14 offset:0
    v_mfma_f32_16x16x32_bf16 v[148:151], v[96:99], v[52:55], v[148:151]
    ds_read_b64_tr_b16 v[74:75], v14 offset:512
    v_mfma_f32_16x16x32_bf16 v[152:155], v[96:99], v[56:59], v[152:155]
    ds_read_b64_tr_b16 v[76:77], v15 offset:0
    v_mfma_f32_16x16x32_bf16 v[156:159], v[96:99], v[60:63], v[156:159]
    ds_read_b64_tr_b16 v[78:79], v15 offset:512
    v_mfma_f32_16x16x32_bf16 v[160:163], v[100:103], v[48:51], v[160:163]
    v_mfma_f32_16x16x32_bf16 v[164:167], v[100:103], v[52:55], v[164:167]
    v_mfma_f32_16x16x32_bf16 v[168:171], v[100:103], v[56:59], v[168:171]
    v_mfma_f32_16x16x32_bf16 v[172:175], v[100:103], v[60:63], v[172:175]
    s_waitcnt vmcnt(9) lgkmcnt(0)
    s_barrier
    s_add_u32 m0, s5, 61440
    s_nop 0
    buffer_load_dwordx4 v2, s[28:31], s68 offen lds
    s_add_u32 s68, s68, s4
    s_add_u32 m0, s5, 65536
    s_nop 0
    buffer_load_dwordx4 v3, s[32:35], s69 offen lds
    s_add_u32 s69, s69, s4
    s_add_u32 m0, s5, 69632
    s_nop 0
    buffer_load_dwordx4 v4, s[36:39], s70 offen lds
    s_add_u32 s70, s70, s4
    s_add_u32 m0, s5, 73728
    s_nop 0
    buffer_load_dwordx4 v5, s[40:43], s71 offen lds
    s_add_u32 s71, s71, 114688
    s_add_u32 m0, s5, 77824
    s_nop 0
    buffer_load_dwordx4 v6, s[44:47], s72 offen lds
    s_add_u32 s72, s72, 114688
    v_mfma_f32_16x16x32_bf16 v[112:115], v[64:67], v[32:35], v[112:115]
    ds_read_b128 v[48:51], v10 offset:0
    v_mfma_f32_16x16x32_bf16 v[116:119], v[64:67], v[36:39], v[116:119]
    ds_read_b128 v[52:55], v10 offset:2048
    v_mfma_f32_16x16x32_bf16 v[120:123], v[64:67], v[40:43], v[120:123]
    ds_read_b128 v[56:59], v10 offset:4096
    v_mfma_f32_16x16x32_bf16 v[124:127], v[64:67], v[44:47], v[124:127]
    ds_read_b128 v[60:63], v10 offset:6144
    v_mfma_f32_16x16x32_bf16 v[128:131], v[68:71], v[32:35], v[128:131]
    ds_read_b64_tr_b16 v[88:89], v12 offset:20480
    v_mfma_f32_16x16x32_bf16 v[132:135], v[68:71], v[36:39], v[132:135]
    ds_read_b64_tr_b16 v[90:91], v12 offset:20992
    v_mfma_f32_16x16x32_bf16 v[136:139], v[68:71], v[40:43], v[136:139]
    ds_read_b64_tr_b16 v[92:93], v13 offset:20480
    v_mfma_f32_16x16x32_bf16 v[140:143], v[68:71], v[44:47], v[140:143]
    ds_read_b64_tr_b16 v[94:95], v13 offset:20992
    v_mfma_f32_16x16x32_bf16 v[144:147], v[72:75], v[32:35], v[144:147]
    ds_read_b64_tr_b16 v[96:97], v14 offset:20480
    v_mfma_f32_16x16x32_bf16 v[148:151], v[72:75], v[36:39], v[148:151]
    ds_read_b64_tr_b16 v[98:99], v14 offset:20992
    v_mfma_f32_16x16x32_bf16 v[152:155], v[72:75], v[40:43], v[152:155]
    ds_read_b64_tr_b16 v[100:101], v15 offset:20480
    v_mfma_f32_16x16x32_bf16 v[156:159], v[72:75], v[44:47], v[156:159]
    ds_read_b64_tr_b16 v[102:103], v15 offset:20992
    v_mfma_f32_16x16x32_bf16 v[160:163], v[76:79], v[32:35], v[160:163]
    v_mfma_f32_16x16x32_bf16 v[164:167], v[76:79], v[36:39], v[164:167]
    v_mfma_f32_16x16x32_bf16 v[168:171], v[76:79], v[40:43], v[168:171]
    v_mfma_f32_16x16x32_bf16 v[172:175], v[76:79], v[44:47], v[172:175]
    s_waitcnt vmcnt(5) lgkmcnt(0)
    s_barrier
    s_add_u32 m0, s5, 0
    s_nop 0
    buffer_load_dwordx4 v2, s[28:31], s68 offen lds
    s_add_u32 s68, s68, s4
    s_add_u32 m0, s5, 4096
    s_nop 0
    buffer_load_dwordx4 v3, s[32:35], s69 offen lds
    s_add_u32 s69, s69, s4
    s_add_u32 m0, s5, 8192
    s_nop 0
    buffer_load_dwordx4 v4, s[36:39], s70 offen lds
    s_add_u32 s70, s70, s4
    s_add_u32 m0, s5, 12288
    s_nop 0
    buffer_load_dwordx4 v5, s[40:43], s71 offen lds
    s_add_u32 s71, s71, 114688
    s_add_u32 m0, s5, 16384
    s_nop 0
    buffer_load_dwordx4 v6, s[44:47], s72 offen lds
    s_add_u32 s72, s72, 114688
    s_add_u32 m0, s6, 0
    s_add_u32 s52, s73, 768
    buffer_load_dwordx4 v7, s[16:19], s52 offen lds
    s_add_u32 m0, s6, 1024
    s_add_u32 s52, s73, 7936
    buffer_load_dwordx4 v8, s[16:19], s52 offen lds
    s_add_u32 m0, s6, 2048
    s_add_u32 s52, s73, 15104
    buffer_load_dwordx4 v7, s[16:19], s52 offen lds
    s_add_u32 m0, s6, 3072
    s_add_u32 s52, s73, 22272
    buffer_load_dwordx4 v8, s[16:19], s52 offen lds
    v_mfma_f32_16x16x32_bf16 v[112:115], v[88:91], v[48:51], v[112:115]
    ds_read_b128 v[32:35], v9 offset:16384
    v_mfma_f32_16x16x32_bf16 v[116:119], v[88:91], v[52:55], v[116:119]
    ds_read_b128 v[36:39], v9 offset:18432
    v_mfma_f32_16x16x32_bf16 v[120:123], v[88:91], v[56:59], v[120:123]
    ds_read_b128 v[40:43], v9 offset:20480
    v_mfma_f32_16x16x32_bf16 v[124:127], v[88:91], v[60:63], v[124:127]
    ds_read_b128 v[44:47], v9 offset:22528
    v_mfma_f32_16x16x32_bf16 v[128:131], v[92:95], v[48:51], v[128:131]
    ds_read_b64_tr_b16 v[64:65], v18 offset:0
    v_mfma_f32_16x16x32_bf16 v[132:135], v[92:95], v[52:55], v[132:135]
    ds_read_b64_tr_b16 v[66:67], v18 offset:512
    v_mfma_f32_16x16x32_bf16 v[136:139], v[92:95], v[56:59], v[136:139]
    ds_read_b64_tr_b16 v[68:69], v19 offset:0
    v_mfma_f32_16x16x32_bf16 v[140:143], v[92:95], v[60:63], v[140:143]
    ds_read_b64_tr_b16 v[70:71], v19 offset:512
    v_mfma_f32_16x16x32_bf16 v[144:147], v[96:99], v[48:51], v[144:147]
    ds_read_b64_tr_b16 v[72:73], v20 offset:0
    v_mfma_f32_16x16x32_bf16 v[148:151], v[96:99], v[52:55], v[148:151]
    ds_read_b64_tr_b16 v[74:75], v20 offset:512
    v_mfma_f32_16x16x32_bf16 v[152:155], v[96:99], v[56:59], v[152:155]
    ds_read_b64_tr_b16 v[76:77], v21 offset:0
    v_mfma_f32_16x16x32_bf16 v[156:159], v[96:99], v[60:63], v[156:159]
    ds_read_b64_tr_b16 v[78:79], v21 offset:512
    v_mfma_f32_16x16x32_bf16 v[160:163], v[100:103], v[48:51], v[160:163]
    v_mfma_f32_16x16x32_bf16 v[164:167], v[100:103], v[52:55], v[164:167]
    v_mfma_f32_16x16x32_bf16 v[168:171], v[100:103], v[56:59], v[168:171]
    v_mfma_f32_16x16x32_bf16 v[172:175], v[100:103], v[60:63], v[172:175]
    s_waitcnt vmcnt(9) lgkmcnt(0)
    s_barrier
    s_add_u32 m0, s5, 20480
    s_nop 0
    buffer_load_dwordx4 v2, s[28:31], s68 offen lds
    s_add_u32 s68, s68, s4
    s_add_u32 m0, s5, 24576
    s_nop 0
    buffer_load_dwordx4 v3, s[32:35], s69 offen lds
    s_add_u32 s69, s69, s4
    s_add_u32 m0, s5, 28672
    s_nop 0
    buffer_load_dwordx4 v4, s[36:39], s70 offen lds
    s_add_u32 s70, s70, s4
    s_add_u32 m0, s5, 32768
    s_nop 0
    buffer_load_dwordx4 v5, s[40:43], s71 offen lds
    s_add_u32 s71, s71, 114688
    s_add_u32 m0, s5, 36864
    s_nop 0
    buffer_load_dwordx4 v6, s[44:47], s72 offen lds
    s_add_u32 s72, s72, 114688
    v_mfma_f32_16x16x32_bf16 v[112:115], v[64:67], v[32:35], v[112:115]
    ds_read_b128 v[48:51], v10 offset:16384
    v_mfma_f32_16x16x32_bf16 v[116:119], v[64:67], v[36:39], v[116:119]
    ds_read_b128 v[52:55], v10 offset:18432
    v_mfma_f32_16x16x32_bf16 v[120:123], v[64:67], v[40:43], v[120:123]
    ds_read_b128 v[56:59], v10 offset:20480
    v_mfma_f32_16x16x32_bf16 v[124:127], v[64:67], v[44:47], v[124:127]
    ds_read_b128 v[60:63], v10 offset:22528
    v_mfma_f32_16x16x32_bf16 v[128:131], v[68:71], v[32:35], v[128:131]
    ds_read_b64_tr_b16 v[88:89], v18 offset:20480
    v_mfma_f32_16x16x32_bf16 v[132:135], v[68:71], v[36:39], v[132:135]
    ds_read_b64_tr_b16 v[90:91], v18 offset:20992
    v_mfma_f32_16x16x32_bf16 v[136:139], v[68:71], v[40:43], v[136:139]
    ds_read_b64_tr_b16 v[92:93], v19 offset:20480
    v_mfma_f32_16x16x32_bf16 v[140:143], v[68:71], v[44:47], v[140:143]
    ds_read_b64_tr_b16 v[94:95], v19 offset:20992
    v_mfma_f32_16x16x32_bf16 v[144:147], v[72:75], v[32:35], v[144:147]
    ds_read_b64_tr_b16 v[96:97], v20 offset:20480
    v_mfma_f32_16x16x32_bf16 v[148:151], v[72:75], v[36:39], v[148:151]
    ds_read_b64_tr_b16 v[98:99], v20 offset:20992
    v_mfma_f32_16x16x32_bf16 v[152:155], v[72:75], v[40:43], v[152:155]
    ds_read_b64_tr_b16 v[100:101], v21 offset:20480
    v_mfma_f32_16x16x32_bf16 v[156:159], v[72:75], v[44:47], v[156:159]
    ds_read_b64_tr_b16 v[102:103], v21 offset:20992
    v_mfma_f32_16x16x32_bf16 v[160:163], v[76:79], v[32:35], v[160:163]
    v_mfma_f32_16x16x32_bf16 v[164:167], v[76:79], v[36:39], v[164:167]
    v_mfma_f32_16x16x32_bf16 v[168:171], v[76:79], v[40:43], v[168:171]
    v_mfma_f32_16x16x32_bf16 v[172:175], v[76:79], v[44:47], v[172:175]
    s_waitcnt vmcnt(5) lgkmcnt(0)
    s_barrier
    s_setprio 0
    v_mfma_f32_16x16x32_bf16 v[112:115], v[88:91], v[48:51], v[112:115]
    ds_read_b128 v[32:35], v9 offset:0
    v_mfma_f32_16x16x32_bf16 v[116:119], v[88:91], v[52:55], v[116:119]
    ds_read_b128 v[36:39], v9 offset:2048
    v_mfma_f32_16x16x32_bf16 v[120:123], v[88:91], v[56:59], v[120:123]
    ds_read_b128 v[40:43], v9 offset:4096
    v_mfma_f32_16x16x32_bf16 v[124:127], v[88:91], v[60:63], v[124:127]
    ds_read_b128 v[44:47], v9 offset:6144
    v_mfma_f32_16x16x32_bf16 v[128:131], v[92:95], v[48:51], v[128:131]
    ds_read_b64_tr_b16 v[64:65], v12 offset:0
    v_mfma_f32_16x16x32_bf16 v[132:135], v[92:95], v[52:55], v[132:135]
    ds_read_b64_tr_b16 v[66:67], v12 offset:512
    v_mfma_f32_16x16x32_bf16 v[136:139], v[92:95], v[56:59], v[136:139]
    ds_read_b64_tr_b16 v[68:69], v13 offset:0
    v_mfma_f32_16x16x32_bf16 v[140:143], v[92:95], v[60:63], v[140:143]
    ds_read_b64_tr_b16 v[70:71], v13 offset:512
    v_mfma_f32_16x16x32_bf16 v[144:147], v[96:99], v[48:51], v[144:147]
    ds_read_b64_tr_b16 v[72:73], v14 offset:0
    v_mfma_f32_16x16x32_bf16 v[148:151], v[96:99], v[52:55], v[148:151]
    ds_read_b64_tr_b16 v[74:75], v14 offset:512
    v_mfma_f32_16x16x32_bf16 v[152:155], v[96:99], v[56:59], v[152:155]
    ds_read_b64_tr_b16 v[76:77], v15 offset:0
    v_mfma_f32_16x16x32_bf16 v[156:159], v[96:99], v[60:63], v[156:159]
    ds_read_b64_tr_b16 v[78:79], v15 offset:512
    v_mfma_f32_16x16x32_bf16 v[160:163], v[100:103], v[48:51], v[160:163]
    v_mfma_f32_16x16x32_bf16 v[164:167], v[100:103], v[52:55], v[164:167]
    v_mfma_f32_16x16x32_bf16 v[168:171], v[100:103], v[56:59], v[168:171]
    v_mfma_f32_16x16x32_bf16 v[172:175], v[100:103], v[60:63], v[172:175]
    s_waitcnt vmcnt(0) lgkmcnt(0)
    s_barrier
    v_mfma_f32_16x16x32_bf16 v[112:115], v[64:67], v[32:35], v[112:115]
    ds_read_b128 v[48:51], v10 offset:0
    v_mfma_f32_16x16x32_bf16 v[116:119], v[64:67], v[36:39], v[116:119]
    ds_read_b128 v[52:55], v10 offset:2048
    v_mfma_f32_16x16x32_bf16 v[120:123], v[64:67], v[40:43], v[120:123]
    ds_read_b128 v[56:59], v10 offset:4096
    v_mfma_f32_16x16x32_bf16 v[124:127], v[64:67], v[44:47], v[124:127]
    ds_read_b128 v[60:63], v10 offset:6144
    v_mfma_f32_16x16x32_bf16 v[128:131], v[68:71], v[32:35], v[128:131]
    ds_read_b64_tr_b16 v[88:89], v12 offset:20480
    v_mfma_f32_16x16x32_bf16 v[132:135], v[68:71], v[36:39], v[132:135]
    ds_read_b64_tr_b16 v[90:91], v12 offset:20992
    v_mfma_f32_16x16x32_bf16 v[136:139], v[68:71], v[40:43], v[136:139]
    ds_read_b64_tr_b16 v[92:93], v13 offset:20480
    v_mfma_f32_16x16x32_bf16 v[140:143], v[68:71], v[44:47], v[140:143]
    ds_read_b64_tr_b16 v[94:95], v13 offset:20992
    v_mfma_f32_16x16x32_bf16 v[144:147], v[72:75], v[32:35], v[144:147]
    ds_read_b64_tr_b16 v[96:97], v14 offset:20480
    v_mfma_f32_16x16x32_bf16 v[148:151], v[72:75], v[36:39], v[148:151]
    ds_read_b64_tr_b16 v[98:99], v14 offset:20992
    v_mfma_f32_16x16x32_bf16 v[152:155], v[72:75], v[40:43], v[152:155]
    ds_read_b64_tr_b16 v[100:101], v15 offset:20480
    v_mfma_f32_16x16x32_bf16 v[156:159], v[72:75], v[44:47], v[156:159]
    ds_read_b64_tr_b16 v[102:103], v15 offset:20992
    v_mfma_f32_16x16x32_bf16 v[160:163], v[76:79], v[32:35], v[160:163]
    v_mfma_f32_16x16x32_bf16 v[164:167], v[76:79], v[36:39], v[164:167]
    v_mfma_f32_16x16x32_bf16 v[168:171], v[76:79], v[40:43], v[168:171]
    v_mfma_f32_16x16x32_bf16 v[172:175], v[76:79], v[44:47], v[172:175]
    s_waitcnt lgkmcnt(0)
    v_mfma_f32_16x16x32_bf16 v[112:115], v[88:91], v[48:51], v[112:115]
    v_mfma_f32_16x16x32_bf16 v[116:119], v[88:91], v[52:55], v[116:119]
    v_mfma_f32_16x16x32_bf16 v[120:123], v[88:91], v[56:59], v[120:123]
    v_mfma_f32_16x16x32_bf16 v[124:127], v[88:91], v[60:63], v[124:127]
    v_mfma_f32_16x16x32_bf16 v[128:131], v[92:95], v[48:51], v[128:131]
    v_mfma_f32_16x16x32_bf16 v[132:135], v[92:95], v[52:55], v[132:135]
    v_mfma_f32_16x16x32_bf16 v[136:139], v[92:95], v[56:59], v[136:139]
    v_mfma_f32_16x16x32_bf16 v[140:143], v[92:95], v[60:63], v[140:143]
    v_mfma_f32_16x16x32_bf16 v[144:147], v[96:99], v[48:51], v[144:147]
    v_mfma_f32_16x16x32_bf16 v[148:151], v[96:99], v[52:55], v[148:151]
    v_mfma_f32_16x16x32_bf16 v[152:155], v[96:99], v[56:59], v[152:155]
    v_mfma_f32_16x16x32_bf16 v[156:159], v[96:99], v[60:63], v[156:159]
    v_mfma_f32_16x16x32_bf16 v[160:163], v[100:103], v[48:51], v[160:163]
    v_mfma_f32_16x16x32_bf16 v[164:167], v[100:103], v[52:55], v[164:167]
    v_mfma_f32_16x16x32_bf16 v[168:171], v[100:103], v[56:59], v[168:171]
    v_mfma_f32_16x16x32_bf16 v[172:175], v[100:103], v[60:63], v[172:175]
    s_mov_b32 s10, 0x3fb8aa3b
    s_mov_b32 s11, 0x3fb8aa3b
    s_mov_b32 s12, 0x358637bd
    s_mov_b32 s13, 0x358637bd
    s_nop 5
    v_mov_b32 v25, 0x7ffffff0
    v_mov_b32 v24, 11599872
    v_cmp_eq_u32 vcc, 0, v1
    s_nop 1
    v_cndmask_b32 v24, v25, v24, vcc
    buffer_store_dword v11, v24, s[20:23], s59 offen
    v_lshlrev_b32 v9, 4, v1
    s_lshl_b32 s52, s56, 2
    s_mul_i32 s53, s56, 10
    s_add_u32 s53, s53, 36
    s_cmp_eq_u32 s57, 0
    s_cselect_b32 s55, s52, s53
    s_and_b32 s53, s50, 2
    s_add_u32 s55, s55, s53
    s_lshr_b32 s53, s55, 1
    s_lshl_b32 s53, s53, 10
    v_pk_mul_f32 v[32:33], v[112:113], s[62:63]
    v_pk_mul_f32 v[34:35], v[114:115], s[62:63]
    v_exp_f32 v32, v32
    v_exp_f32 v33, v33
    v_exp_f32 v34, v34
    v_exp_f32 v35, v35
    v_pk_mul_f32 v[112:113], v[112:113], v[128:129]
    v_pk_mul_f32 v[114:115], v[114:115], v[130:131]
    v_pk_add_f32 v[32:33], v[32:33], s[64:65]
    v_pk_add_f32 v[34:35], v[34:35], s[64:65]
    v_rcp_f32 v32, v32
    v_rcp_f32 v33, v33
    v_rcp_f32 v34, v34
    v_rcp_f32 v35, v35
    s_nop 0
    v_pk_mul_f32 v[112:113], v[112:113], v[32:33]
    v_pk_mul_f32 v[114:115], v[114:115], v[34:35]
    v_cvt_pk_bf16_f32 v48, v112, v113
    v_cvt_pk_bf16_f32 v49, v114, v115
    v_pk_mul_f32 v[36:37], v[144:145], s[62:63]
    v_pk_mul_f32 v[38:39], v[146:147], s[62:63]
    v_exp_f32 v36, v36
    v_exp_f32 v37, v37
    v_exp_f32 v38, v38
    v_exp_f32 v39, v39
    v_pk_mul_f32 v[144:145], v[144:145], v[160:161]
    v_pk_mul_f32 v[146:147], v[146:147], v[162:163]
    v_pk_add_f32 v[36:37], v[36:37], s[64:65]
    v_pk_add_f32 v[38:39], v[38:39], s[64:65]
    v_rcp_f32 v36, v36
    v_rcp_f32 v37, v37
    v_rcp_f32 v38, v38
    v_rcp_f32 v39, v39
    s_nop 0
    v_pk_mul_f32 v[144:145], v[144:145], v[36:37]
    v_pk_mul_f32 v[146:147], v[146:147], v[38:39]
    v_cvt_pk_bf16_f32 v50, v144, v145
    v_cvt_pk_bf16_f32 v51, v146, v147
    s_add_u32 s52, s58, 0
    s_mul_i32 s52, s52, 57344
    s_add_u32 s52, s52, s53
    buffer_store_dwordx4 v[48:51], v9, s[20:23], s52 offen
    v_pk_mul_f32 v[32:33], v[116:117], s[62:63]
    v_pk_mul_f32 v[34:35], v[118:119], s[62:63]
    v_exp_f32 v32, v32
    v_exp_f32 v33, v33
    v_exp_f32 v34, v34
    v_exp_f32 v35, v35
    v_pk_mul_f32 v[116:117], v[116:117], v[132:133]
    v_pk_mul_f32 v[118:119], v[118:119], v[134:135]
    v_pk_add_f32 v[32:33], v[32:33], s[64:65]
    v_pk_add_f32 v[34:35], v[34:35], s[64:65]
    v_rcp_f32 v32, v32
    v_rcp_f32 v33, v33
    v_rcp_f32 v34, v34
    v_rcp_f32 v35, v35
    s_nop 0
    v_pk_mul_f32 v[116:117], v[116:117], v[32:33]
    v_pk_mul_f32 v[118:119], v[118:119], v[34:35]
    v_cvt_pk_bf16_f32 v52, v116, v117
    v_cvt_pk_bf16_f32 v53, v118, v119
    v_pk_mul_f32 v[36:37], v[148:149], s[62:63]
    v_pk_mul_f32 v[38:39], v[150:151], s[62:63]
    v_exp_f32 v36, v36
    v_exp_f32 v37, v37
    v_exp_f32 v38, v38
    v_exp_f32 v39, v39
    v_pk_mul_f32 v[148:149], v[148:149], v[164:165]
    v_pk_mul_f32 v[150:151], v[150:151], v[166:167]
    v_pk_add_f32 v[36:37], v[36:37], s[64:65]
    v_pk_add_f32 v[38:39], v[38:39], s[64:65]
    v_rcp_f32 v36, v36
    v_rcp_f32 v37, v37
    v_rcp_f32 v38, v38
    v_rcp_f32 v39, v39
    s_nop 0
    v_pk_mul_f32 v[148:149], v[148:149], v[36:37]
    v_pk_mul_f32 v[150:151], v[150:151], v[38:39]
    v_cvt_pk_bf16_f32 v54, v148, v149
    v_cvt_pk_bf16_f32 v55, v150, v151
    s_add_u32 s52, s58, 1
    s_mul_i32 s52, s52, 57344
    s_add_u32 s52, s52, s53
    buffer_store_dwordx4 v[52:55], v9, s[20:23], s52 offen
    v_pk_mul_f32 v[32:33], v[120:121], s[62:63]
    v_pk_mul_f32 v[34:35], v[122:123], s[62:63]
    v_exp_f32 v32, v32
    v_exp_f32 v33, v33
    v_exp_f32 v34, v34
    v_exp_f32 v35, v35
    v_pk_mul_f32 v[120:121], v[120:121], v[136:137]
    v_pk_mul_f32 v[122:123], v[122:123], v[138:139]
    v_pk_add_f32 v[32:33], v[32:33], s[64:65]
    v_pk_add_f32 v[34:35], v[34:35], s[64:65]
    v_rcp_f32 v32, v32
    v_rcp_f32 v33, v33
    v_rcp_f32 v34, v34
    v_rcp_f32 v35, v35
    s_nop 0
    v_pk_mul_f32 v[120:121], v[120:121], v[32:33]
    v_pk_mul_f32 v[122:123], v[122:123], v[34:35]
    v_cvt_pk_bf16_f32 v56, v120, v121
    v_cvt_pk_bf16_f32 v57, v122, v123
    v_pk_mul_f32 v[36:37], v[152:153], s[62:63]
    v_pk_mul_f32 v[38:39], v[154:155], s[62:63]
    v_exp_f32 v36, v36
    v_exp_f32 v37, v37
    v_exp_f32 v38, v38
    v_exp_f32 v39, v39
    v_pk_mul_f32 v[152:153], v[152:153], v[168:169]
    v_pk_mul_f32 v[154:155], v[154:155], v[170:171]
    v_pk_add_f32 v[36:37], v[36:37], s[64:65]
    v_pk_add_f32 v[38:39], v[38:39], s[64:65]
    v_rcp_f32 v36, v36
    v_rcp_f32 v37, v37
    v_rcp_f32 v38, v38
    v_rcp_f32 v39, v39
    s_nop 0
    v_pk_mul_f32 v[152:153], v[152:153], v[36:37]
    v_pk_mul_f32 v[154:155], v[154:155], v[38:39]
    v_cvt_pk_bf16_f32 v58, v152, v153
    v_cvt_pk_bf16_f32 v59, v154, v155
    s_add_u32 s52, s58, 2
    s_mul_i32 s52, s52, 57344
    s_add_u32 s52, s52, s53
    buffer_store_dwordx4 v[56:59], v9, s[20:23], s52 offen
    v_pk_mul_f32 v[32:33], v[124:125], s[62:63]
    v_pk_mul_f32 v[34:35], v[126:127], s[62:63]
    v_exp_f32 v32, v32
    v_exp_f32 v33, v33
    v_exp_f32 v34, v34
    v_exp_f32 v35, v35
    v_pk_mul_f32 v[124:125], v[124:125], v[140:141]
    v_pk_mul_f32 v[126:127], v[126:127], v[142:143]
    v_pk_add_f32 v[32:33], v[32:33], s[64:65]
    v_pk_add_f32 v[34:35], v[34:35], s[64:65]
    v_rcp_f32 v32, v32
    v_rcp_f32 v33, v33
    v_rcp_f32 v34, v34
    v_rcp_f32 v35, v35
    s_nop 0
    v_pk_mul_f32 v[124:125], v[124:125], v[32:33]
    v_pk_mul_f32 v[126:127], v[126:127], v[34:35]
    v_cvt_pk_bf16_f32 v60, v124, v125
    v_cvt_pk_bf16_f32 v61, v126, v127
    v_pk_mul_f32 v[36:37], v[156:157], s[62:63]
    v_pk_mul_f32 v[38:39], v[158:159], s[62:63]
    v_exp_f32 v36, v36
    v_exp_f32 v37, v37
    v_exp_f32 v38, v38
    v_exp_f32 v39, v39
    v_pk_mul_f32 v[156:157], v[156:157], v[172:173]
    v_pk_mul_f32 v[158:159], v[158:159], v[174:175]
    v_pk_add_f32 v[36:37], v[36:37], s[64:65]
    v_pk_add_f32 v[38:39], v[38:39], s[64:65]
    v_rcp_f32 v36, v36
    v_rcp_f32 v37, v37
    v_rcp_f32 v38, v38
    v_rcp_f32 v39, v39
    s_nop 0
    v_pk_mul_f32 v[156:157], v[156:157], v[36:37]
    v_pk_mul_f32 v[158:159], v[158:159], v[38:39]
    v_cvt_pk_bf16_f32 v62, v156, v157
    v_cvt_pk_bf16_f32 v63, v158, v159
    s_add_u32 s52, s58, 3
    s_mul_i32 s52, s52, 57344
    s_add_u32 s52, s52, s53
    buffer_store_dwordx4 v[60:63], v9, s[20:23], s52 offen
K1_END:
    s_endpgm
.globl k2_kernel
.p2align 8
.type k2_kernel,@function
k2_kernel:
    s_cmp_ge_u32 s2, 240
    s_cbranch_scc1 K2_END
    s_load_dwordx2 s[98:99], s[0:1], 16
    s_load_dwordx2 s[96:97], s[0:1], 48
    s_load_dwordx4 s[8:11], s[0:1], 64
    s_load_dwordx2 s[14:15], s[0:1], 80
    s_getpc_b64 s[100:101]
K2_PC:
    s_sub_u32 s100, s100, K2_PC-k2_kernel
    s_subb_u32 s101, s101, 0
    v_lshlrev_b32 v11, 7, v0
    v_min_u32 v11, K2_END-k2_kernel, v11
    global_load_dword v7, v11, s[100:101]
    v_and_b32 v1, 63, v0
    v_lshrrev_b32 v11, 6, v0
    s_nop 0
    v_readfirstlane_b32 s50, v11
    v_lshlrev_b32 v2, 4, v1
    s_mov_b32 s60, 0xffff0000
    s_mov_b32 s62, 0xbfb8aa3b
    s_mov_b32 s63, 0xbfb8aa3b
    s_mov_b32 s64, 1.0
    s_mov_b32 s65, 1.0
    s_mov_b32 s66, 0x3fb8aa3b
    s_mov_b32 s67, 0x358637bd
    s_and_b32 s52, s2, 7
    s_lshr_b32 s75, s2, 3
    s_sub_u32 s53, s75, 2
    s_lshl_b32 s54, s52, 2
    s_and_b32 s55, s53, 3
    s_add_u32 s44, s54, s55
    s_lshr_b32 s45, s53, 2
    s_waitcnt lgkmcnt(0)
    s_mov_b32 s28, s96
    s_and_b32 s29, s97, 0xffff
    s_mov_b32 s30, 0x188000
    s_mov_b32 s31, 0x00020000
    s_mov_b32 s32, s98
    s_and_b32 s33, s99, 0xffff
    s_mov_b32 s34, 0x62000
    s_mov_b32 s35, 0x00020000
    s_mov_b32 s20, s14
    s_and_b32 s21, s15, 0xffff
    s_mov_b32 s22, 0xb20000
    s_mov_b32 s23, 0x00020000
    s_mov_b32 s36, s8
    s_and_b32 s37, s9, 0xffff
    s_mov_b32 s38, 0x1c0000
    s_mov_b32 s39, 0x00020000
    s_mov_b32 s40, s10
    s_and_b32 s41, s11, 0xffff
    s_mov_b32 s42, 0x100
    s_mov_b32 s43, 0x00020000
    s_cmp_lt_u32 s75, 2
    s_cbranch_scc1 K2_RED
    s_mul_i32 s46, s50, 32768
    s_mul_i32 s52, s50, 401408
    s_lshl_b32 s53, s45, 7
    s_add_u32 s47, s52, s53
    s_mul_i32 s52, s50, 100352
    s_add_u32 s68, s52, s53
    s_mul_i32 s52, s44, 229376
    s_mul_i32 s53, s50, 14336
    s_add_u32 s69, s52, s53
    s_lshl_b32 s52, s44, 16
    s_lshl_b32 s53, s50, 12
    s_add_u32 s52, s52, s53
    s_add_u32 s70, s52, 7340032
    s_lshl_b32 s52, s50, 13
    s_add_u32 s71, s52, 11534336
    v_lshrrev_b32 v11, 3, v1
    v_lshrrev_b32 v12, 4, v1
    v_lshrrev_b32 v13, 1, v1
    v_xor_b32 v12, v12, v13
    v_and_b32 v12, 3, v12
    v_lshlrev_b32 v12, 5, v12
    v_mul_u32_u24 v11, 896, v11
    v_and_b32 v13, 1, v1
    v_lshlrev_b32 v13, 4, v13
    v_add3_u32 v31, v11, v12, v13
    s_add_u32 m0, s46, 0
    s_add_u32 s52, s47, 0
    buffer_load_dwordx4 v31, s[28:31], s52 offen lds
    s_add_u32 m0, s46, 1024
    s_add_u32 s52, s47, 7168
    buffer_load_dwordx4 v31, s[28:31], s52 offen lds
    s_add_u32 m0, s46, 2048
    s_add_u32 s52, s47, 14336
    buffer_load_dwordx4 v31, s[28:31], s52 offen lds
    s_add_u32 m0, s46, 3072
    s_add_u32 s52, s47, 21504
    buffer_load_dwordx4 v31, s[28:31], s52 offen lds
    s_add_u32 m0, s46, 4096
    s_add_u32 s52, s69, 0
    buffer_load_dwordx4 v2, s[20:23], s52 offen lds
    s_add_u32 m0, s46, 5120
    s_add_u32 s52, s69, 57344
    buffer_load_dwordx4 v2, s[20:23], s52 offen lds
    s_add_u32 m0, s46, 6144
    s_add_u32 s52, s69, 114688
    buffer_load_dwordx4 v2, s[20:23], s52 offen lds
    s_add_u32 m0, s46, 7168
    s_add_u32 s52, s69, 172032
    buffer_load_dwordx4 v2, s[20:23], s52 offen lds
    s_add_u32 m0, s46, 8192
    s_add_u32 s52, s47, 28672
    buffer_load_dwordx4 v31, s[28:31], s52 offen lds
    s_add_u32 m0, s46, 9216
    s_add_u32 s52, s47, 35840
    buffer_load_dwordx4 v31, s[28:31], s52 offen lds
    s_add_u32 m0, s46, 10240
    s_add_u32 s52, s47, 43008
    buffer_load_dwordx4 v31, s[28:31], s52 offen lds
    s_add_u32 m0, s46, 11264
    s_add_u32 s52, s47, 50176
    buffer_load_dwordx4 v31, s[28:31], s52 offen lds
    s_add_u32 m0, s46, 12288
    s_add_u32 s52, s69, 1024
    buffer_load_dwordx4 v2, s[20:23], s52 offen lds
    s_add_u32 m0, s46, 13312
    s_add_u32 s52, s69, 58368
    buffer_load_dwordx4 v2, s[20:23], s52 offen lds
    s_add_u32 m0, s46, 14336
    s_add_u32 s52, s69, 115712
    buffer_load_dwordx4 v2, s[20:23], s52 offen lds
    s_add_u32 m0, s46, 15360
    s_add_u32 s52, s69, 173056
    buffer_load_dwordx4 v2, s[20:23], s52 offen lds
    s_add_u32 m0, s46, 16384
    s_add_u32 s52, s47, 57344
    buffer_load_dwordx4 v31, s[28:31], s52 offen lds
    s_add_u32 m0, s46, 17408
    s_add_u32 s52, s47, 64512
    buffer_load_dwordx4 v31, s[28:31], s52 offen lds
    s_add_u32 m0, s46, 18432
    s_add_u32 s52, s47, 71680
    buffer_load_dwordx4 v31, s[28:31], s52 offen lds
    s_add_u32 m0, s46, 19456
    s_add_u32 s52, s47, 78848
    buffer_load_dwordx4 v31, s[28:31], s52 offen lds
    s_add_u32 m0, s46, 20480
    s_add_u32 s52, s69, 2048
    buffer_load_dwordx4 v2, s[20:23], s52 offen lds
    s_add_u32 m0, s46, 21504
    s_add_u32 s52, s69, 59392
    buffer_load_dwordx4 v2, s[20:23], s52 offen lds
    s_add_u32 m0, s46, 22528
    s_add_u32 s52, s69, 116736
    buffer_load_dwordx4 v2, s[20:23], s52 offen lds
    s_add_u32 m0, s46, 23552
    s_add_u32 s52, s69, 174080
    buffer_load_dwordx4 v2, s[20:23], s52 offen lds
    v_lshrrev_b32 v11, 4, v1
    v_lshrrev_b32 v12, 2, v1
    v_and_b32 v12, 3, v12
    v_and_b32 v13, 3, v1
    v_lshlrev_b32 v3, 3, v13
    v_and_b32 v13, 1, v11
    v_lshrrev_b32 v14, 1, v11
    v_lshl_add_u32 v3, v14, 10, v3
    v_lshl_add_u32 v3, v13, 9, v3
    v_lshl_add_u32 v3, v12, 7, v3
    v_lshrrev_b32 v14, 1, v12
    v_lshl_or_b32 v14, v13, 1, v14
    v_xor_b32 v14, 0, v14
    v_lshl_add_u32 v3, v14, 5, v3
    v_add_u32 v3, s46, v3
    v_lshrrev_b32 v11, 4, v1
    v_lshrrev_b32 v12, 2, v1
    v_and_b32 v12, 3, v12
    v_and_b32 v13, 3, v1
    v_lshlrev_b32 v4, 3, v13
    v_and_b32 v13, 1, v11
    v_lshrrev_b32 v14, 1, v11
    v_lshl_add_u32 v4, v14, 10, v4
    v_lshl_add_u32 v4, v13, 9, v4
    v_lshl_add_u32 v4, v12, 7, v4
    v_lshrrev_b32 v14, 1, v12
    v_lshl_or_b32 v14, v13, 1, v14
    v_xor_b32 v14, 1, v14
    v_lshl_add_u32 v4, v14, 5, v4
    v_add_u32 v4, s46, v4
    v_lshrrev_b32 v11, 4, v1
    v_lshrrev_b32 v12, 2, v1
    v_and_b32 v12, 3, v12
    v_and_b32 v13, 3, v1
    v_lshlrev_b32 v5, 3, v13
    v_and_b32 v13, 1, v11
    v_lshrrev_b32 v14, 1, v11
    v_lshl_add_u32 v5, v14, 10, v5
    v_lshl_add_u32 v5, v13, 9, v5
    v_lshl_add_u32 v5, v12, 7, v5
    v_lshrrev_b32 v14, 1, v12
    v_lshl_or_b32 v14, v13, 1, v14
    v_xor_b32 v14, 2, v14
    v_lshl_add_u32 v5, v14, 5, v5
    v_add_u32 v5, s46, v5
    v_lshrrev_b32 v11, 4, v1
    v_lshrrev_b32 v12, 2, v1
    v_and_b32 v12, 3, v12
    v_and_b32 v13, 3, v1
    v_lshlrev_b32 v6, 3, v13
    v_and_b32 v13, 1, v11
    v_lshrrev_b32 v14, 1, v11
    v_lshl_add_u32 v6, v14, 10, v6
    v_lshl_add_u32 v6, v13, 9, v6
    v_lshl_add_u32 v6, v12, 7, v6
    v_lshrrev_b32 v14, 1, v12
    v_lshl_or_b32 v14, v13, 1, v14
    v_xor_b32 v14, 3, v14
    v_lshl_add_u32 v6, v14, 5, v6
    v_add_u32 v6, s46, v6
    v_add_u32 v10, s46, v2
    v_lshrrev_b32 v11, 4, v1
    v_lshlrev_b32 v11, 8, v11
    v_add_u32 v8, 1216, v11
    s_waitcnt vmcnt(16)
    ds_read_b128 v[64:67], v10 offset:4096
    ds_read_b128 v[68:71], v10 offset:5120
    ds_read_b128 v[72:75], v10 offset:6144
    ds_read_b128 v[76:79], v10 offset:7168
    ds_read_b64_tr_b16 v[32:33], v3 offset:0
    ds_read_b64_tr_b16 v[34:35], v3 offset:2048
    ds_read_b64_tr_b16 v[36:37], v4 offset:0
    ds_read_b64_tr_b16 v[38:39], v4 offset:2048
    ds_read_b64_tr_b16 v[40:41], v5 offset:0
    ds_read_b64_tr_b16 v[42:43], v5 offset:2048
    ds_read_b64_tr_b16 v[44:45], v6 offset:0
    ds_read_b64_tr_b16 v[46:47], v6 offset:2048
    s_waitcnt vmcnt(8) lgkmcnt(0)
    s_add_u32 m0, s46, 24576
    s_add_u32 s52, s47, 86016
    buffer_load_dwordx4 v31, s[28:31], s52 offen lds
    s_add_u32 m0, s46, 25600
    s_add_u32 s52, s47, 93184
    buffer_load_dwordx4 v31, s[28:31], s52 offen lds
    s_add_u32 m0, s46, 26624
    s_add_u32 s52, s47, 100352
    buffer_load_dwordx4 v31, s[28:31], s52 offen lds
    s_add_u32 m0, s46, 27648
    s_add_u32 s52, s47, 107520
    buffer_load_dwordx4 v31, s[28:31], s52 offen lds
    s_add_u32 m0, s46, 28672
    s_add_u32 s52, s69, 3072
    buffer_load_dwordx4 v2, s[20:23], s52 offen lds
    s_add_u32 m0, s46, 29696
    s_add_u32 s52, s69, 60416
    buffer_load_dwordx4 v2, s[20:23], s52 offen lds
    s_add_u32 m0, s46, 30720
    s_add_u32 s52, s69, 117760
    buffer_load_dwordx4 v2, s[20:23], s52 offen lds
    s_add_u32 m0, s46, 31744
    s_add_u32 s52, s69, 175104
    buffer_load_dwordx4 v2, s[20:23], s52 offen lds
    v_mfma_f32_16x16x32_bf16 v[128:131], v[32:35], v[64:67], 0
    ds_read_b128 v[80:83], v10 offset:12288
    v_mfma_f32_16x16x32_bf16 v[132:135], v[32:35], v[68:71], 0
    ds_read_b128 v[84:87], v10 offset:13312
    v_mfma_f32_16x16x32_bf16 v[136:139], v[32:35], v[72:75], 0
    ds_read_b128 v[88:91], v10 offset:14336
    v_mfma_f32_16x16x32_bf16 v[140:143], v[32:35], v[76:79], 0
    ds_read_b128 v[92:95], v10 offset:15360
    v_mfma_f32_16x16x32_bf16 v[144:147], v[36:39], v[64:67], 0
    ds_read_b64_tr_b16 v[48:49], v3 offset:8192
    v_mfma_f32_16x16x32_bf16 v[148:151], v[36:39], v[68:71], 0
    ds_read_b64_tr_b16 v[50:51], v3 offset:10240
    v_mfma_f32_16x16x32_bf16 v[152:155], v[36:39], v[72:75], 0
    ds_read_b64_tr_b16 v[52:53], v4 offset:8192
    v_mfma_f32_16x16x32_bf16 v[156:159], v[36:39], v[76:79], 0
    ds_read_b64_tr_b16 v[54:55], v4 offset:10240
    v_mfma_f32_16x16x32_bf16 v[160:163], v[40:43], v[64:67], 0
    ds_read_b64_tr_b16 v[56:57], v5 offset:8192
    v_mfma_f32_16x16x32_bf16 v[164:167], v[40:43], v[68:71], 0
    ds_read_b64_tr_b16 v[58:59], v5 offset:10240
    v_mfma_f32_16x16x32_bf16 v[168:171], v[40:43], v[72:75], 0
    ds_read_b64_tr_b16 v[60:61], v6 offset:8192
    v_mfma_f32_16x16x32_bf16 v[172:175], v[40:43], v[76:79], 0
    ds_read_b64_tr_b16 v[62:63], v6 offset:10240
    v_mfma_f32_16x16x32_bf16 v[176:179], v[44:47], v[64:67], 0
    v_mfma_f32_16x16x32_bf16 v[180:183], v[44:47], v[68:71], 0
    v_mfma_f32_16x16x32_bf16 v[184:187], v[44:47], v[72:75], 0
    v_mfma_f32_16x16x32_bf16 v[188:191], v[44:47], v[76:79], 0
    s_waitcnt vmcnt(8) lgkmcnt(0)
    s_add_u32 m0, s46, 0
    s_add_u32 s52, s47, 114688
    buffer_load_dwordx4 v31, s[28:31], s52 offen lds
    s_add_u32 m0, s46, 1024
    s_add_u32 s52, s47, 121856
    buffer_load_dwordx4 v31, s[28:31], s52 offen lds
    s_add_u32 m0, s46, 2048
    s_add_u32 s52, s47, 129024
    buffer_load_dwordx4 v31, s[28:31], s52 offen lds
    s_add_u32 m0, s46, 3072
    s_add_u32 s52, s47, 136192
    buffer_load_dwordx4 v31, s[28:31], s52 offen lds
    s_add_u32 m0, s46, 4096
    s_add_u32 s52, s69, 4096
    buffer_load_dwordx4 v2, s[20:23], s52 offen lds
    s_add_u32 m0, s46, 5120
    s_add_u32 s52, s69, 61440
    buffer_load_dwordx4 v2, s[20:23], s52 offen lds
    s_add_u32 m0, s46, 6144
    s_add_u32 s52, s69, 118784
    buffer_load_dwordx4 v2, s[20:23], s52 offen lds
    s_add_u32 m0, s46, 7168
    s_add_u32 s52, s69, 176128
    buffer_load_dwordx4 v2, s[20:23], s52 offen lds
    v_mfma_f32_16x16x32_bf16 v[128:131], v[48:51], v[80:83], v[128:131]
    ds_read_b128 v[64:67], v10 offset:20480
    v_mfma_f32_16x16x32_bf16 v[132:135], v[48:51], v[84:87], v[132:135]
    ds_read_b128 v[68:71], v10 offset:21504
    v_mfma_f32_16x16x32_bf16 v[136:139], v[48:51], v[88:91], v[136:139]
    ds_read_b128 v[72:75], v10 offset:22528
    v_mfma_f32_16x16x32_bf16 v[140:143], v[48:51], v[92:95], v[140:143]
    ds_read_b128 v[76:79], v10 offset:23552
    v_mfma_f32_16x16x32_bf16 v[144:147], v[52:55], v[80:83], v[144:147]
    ds_read_b64_tr_b16 v[32:33], v3 offset:16384
    v_mfma_f32_16x16x32_bf16 v[148:151], v[52:55], v[84:87], v[148:151]
    ds_read_b64_tr_b16 v[34:35], v3 offset:18432
    v_mfma_f32_16x16x32_bf16 v[152:155], v[52:55], v[88:91], v[152:155]
    ds_read_b64_tr_b16 v[36:37], v4 offset:16384
    v_mfma_f32_16x16x32_bf16 v[156:159], v[52:55], v[92:95], v[156:159]
    ds_read_b64_tr_b16 v[38:39], v4 offset:18432
    v_mfma_f32_16x16x32_bf16 v[160:163], v[56:59], v[80:83], v[160:163]
    ds_read_b64_tr_b16 v[40:41], v5 offset:16384
    v_mfma_f32_16x16x32_bf16 v[164:167], v[56:59], v[84:87], v[164:167]
    ds_read_b64_tr_b16 v[42:43], v5 offset:18432
    v_mfma_f32_16x16x32_bf16 v[168:171], v[56:59], v[88:91], v[168:171]
    ds_read_b64_tr_b16 v[44:45], v6 offset:16384
    v_mfma_f32_16x16x32_bf16 v[172:175], v[56:59], v[92:95], v[172:175]
    ds_read_b64_tr_b16 v[46:47], v6 offset:18432
    v_mfma_f32_16x16x32_bf16 v[176:179], v[60:63], v[80:83], v[176:179]
    v_mfma_f32_16x16x32_bf16 v[180:183], v[60:63], v[84:87], v[180:183]
    v_mfma_f32_16x16x32_bf16 v[184:187], v[60:63], v[88:91], v[184:187]
    v_mfma_f32_16x16x32_bf16 v[188:191], v[60:63], v[92:95], v[188:191]
    s_waitcnt vmcnt(8) lgkmcnt(0)
    s_add_u32 m0, s46, 8192
    s_add_u32 s52, s47, 143360
    buffer_load_dwordx4 v31, s[28:31], s52 offen lds
    s_add_u32 m0, s46, 9216
    s_add_u32 s52, s47, 150528
    buffer_load_dwordx4 v31, s[28:31], s52 offen lds
    s_add_u32 m0, s46, 10240
    s_add_u32 s52, s47, 157696
    buffer_load_dwordx4 v31, s[28:31], s52 offen lds
    s_add_u32 m0, s46, 11264
    s_add_u32 s52, s47, 164864
    buffer_load_dwordx4 v31, s[28:31], s52 offen lds
    s_add_u32 m0, s46, 12288
    s_add_u32 s52, s69, 5120
    buffer_load_dwordx4 v2, s[20:23], s52 offen lds
    s_add_u32 m0, s46, 13312
    s_add_u32 s52, s69, 62464
    buffer_load_dwordx4 v2, s[20:23], s52 offen lds
    s_add_u32 m0, s46, 14336
    s_add_u32 s52, s69, 119808
    buffer_load_dwordx4 v2, s[20:23], s52 offen lds
    s_add_u32 m0, s46, 15360
    s_add_u32 s52, s69, 177152
    buffer_load_dwordx4 v2, s[20:23], s52 offen lds
    v_mfma_f32_16x16x32_bf16 v[128:131], v[32:35], v[64:67], v[128:131]
    ds_read_b128 v[80:83], v10 offset:28672
    v_mfma_f32_16x16x32_bf16 v[132:135], v[32:35], v[68:71], v[132:135]
    ds_read_b128 v[84:87], v10 offset:29696
    v_mfma_f32_16x16x32_bf16 v[136:139], v[32:35], v[72:75], v[136:139]
    ds_read_b128 v[88:91], v10 offset:30720
    v_mfma_f32_16x16x32_bf16 v[140:143], v[32:35], v[76:79], v[140:143]
    ds_read_b128 v[92:95], v10 offset:31744
    v_mfma_f32_16x16x32_bf16 v[144:147], v[36:39], v[64:67], v[144:147]
    ds_read_b64_tr_b16 v[48:49], v3 offset:24576
    v_mfma_f32_16x16x32_bf16 v[148:151], v[36:39], v[68:71], v[148:151]
    ds_read_b64_tr_b16 v[50:51], v3 offset:26624
    v_mfma_f32_16x16x32_bf16 v[152:155], v[36:39], v[72:75], v[152:155]
    ds_read_b64_tr_b16 v[52:53], v4 offset:24576
    v_mfma_f32_16x16x32_bf16 v[156:159], v[36:39], v[76:79], v[156:159]
    ds_read_b64_tr_b16 v[54:55], v4 offset:26624
    v_mfma_f32_16x16x32_bf16 v[160:163], v[40:43], v[64:67], v[160:163]
    ds_read_b64_tr_b16 v[56:57], v5 offset:24576
    v_mfma_f32_16x16x32_bf16 v[164:167], v[40:43], v[68:71], v[164:167]
    ds_read_b64_tr_b16 v[58:59], v5 offset:26624
    v_mfma_f32_16x16x32_bf16 v[168:171], v[40:43], v[72:75], v[168:171]
    ds_read_b64_tr_b16 v[60:61], v6 offset:24576
    v_mfma_f32_16x16x32_bf16 v[172:175], v[40:43], v[76:79], v[172:175]
    ds_read_b64_tr_b16 v[62:63], v6 offset:26624
    v_mfma_f32_16x16x32_bf16 v[176:179], v[44:47], v[64:67], v[176:179]
    v_mfma_f32_16x16x32_bf16 v[180:183], v[44:47], v[68:71], v[180:183]
    v_mfma_f32_16x16x32_bf16 v[184:187], v[44:47], v[72:75], v[184:187]
    v_mfma_f32_16x16x32_bf16 v[188:191], v[44:47], v[76:79], v[188:191]
    s_waitcnt vmcnt(8) lgkmcnt(0)
    s_add_u32 m0, s46, 16384
    s_add_u32 s52, s47, 172032
    buffer_load_dwordx4 v31, s[28:31], s52 offen lds
    s_add_u32 m0, s46, 17408
    s_add_u32 s52, s47, 179200
    buffer_load_dwordx4 v31, s[28:31], s52 offen lds
    s_add_u32 m0, s46, 18432
    s_add_u32 s52, s47, 186368
    buffer_load_dwordx4 v31, s[28:31], s52 offen lds
    s_add_u32 m0, s46, 19456
    s_add_u32 s52, s47, 193536
    buffer_load_dwordx4 v31, s[28:31], s52 offen lds
    s_add_u32 m0, s46, 20480
    s_add_u32 s52, s69, 6144
    buffer_load_dwordx4 v2, s[20:23], s52 offen lds
    s_add_u32 m0, s46, 21504
    s_add_u32 s52, s69, 63488
    buffer_load_dwordx4 v2, s[20:23], s52 offen lds
    s_add_u32 m0, s46, 22528
    s_add_u32 s52, s69, 120832
    buffer_load_dwordx4 v2, s[20:23], s52 offen lds
    s_add_u32 m0, s46, 23552
    s_add_u32 s52, s69, 178176
    buffer_load_dwordx4 v2, s[20:23], s52 offen lds
    v_mfma_f32_16x16x32_bf16 v[128:131], v[48:51], v[80:83], v[128:131]
    ds_read_b128 v[64:67], v10 offset:4096
    v_mfma_f32_16x16x32_bf16 v[132:135], v[48:51], v[84:87], v[132:135]
    ds_read_b128 v[68:71], v10 offset:5120
    v_mfma_f32_16x16x32_bf16 v[136:139], v[48:51], v[88:91], v[136:139]
    ds_read_b128 v[72:75], v10 offset:6144
    v_mfma_f32_16x16x32_bf16 v[140:143], v[48:51], v[92:95], v[140:143]
    ds_read_b128 v[76:79], v10 offset:7168
    v_mfma_f32_16x16x32_bf16 v[144:147], v[52:55], v[80:83], v[144:147]
    ds_read_b64_tr_b16 v[32:33], v3 offset:0
    v_mfma_f32_16x16x32_bf16 v[148:151], v[52:55], v[84:87], v[148:151]
    ds_read_b64_tr_b16 v[34:35], v3 offset:2048
    v_mfma_f32_16x16x32_bf16 v[152:155], v[52:55], v[88:91], v[152:155]
    ds_read_b64_tr_b16 v[36:37], v4 offset:0
    v_mfma_f32_16x16x32_bf16 v[156:159], v[52:55], v[92:95], v[156:159]
    ds_read_b64_tr_b16 v[38:39], v4 offset:2048
    v_mfma_f32_16x16x32_bf16 v[160:163], v[56:59], v[80:83], v[160:163]
    ds_read_b64_tr_b16 v[40:41], v5 offset:0
    v_mfma_f32_16x16x32_bf16 v[164:167], v[56:59], v[84:87], v[164:167]
    ds_read_b64_tr_b16 v[42:43], v5 offset:2048
    v_mfma_f32_16x16x32_bf16 v[168:171], v[56:59], v[88:91], v[168:171]
    ds_read_b64_tr_b16 v[44:45], v6 offset:0
    v_mfma_f32_16x16x32_bf16 v[172:175], v[56:59], v[92:95], v[172:175]
    ds_read_b64_tr_b16 v[46:47], v6 offset:2048
    v_mfma_f32_16x16x32_bf16 v[176:179], v[60:63], v[80:83], v[176:179]
    v_mfma_f32_16x16x32_bf16 v[180:183], v[60:63], v[84:87], v[180:183]
    v_mfma_f32_16x16x32_bf16 v[184:187], v[60:63], v[88:91], v[184:187]
    v_mfma_f32_16x16x32_bf16 v[188:191], v[60:63], v[92:95], v[188:191]
    s_waitcnt vmcnt(8) lgkmcnt(0)
    s_add_u32 m0, s46, 24576
    s_add_u32 s52, s47, 200704
    buffer_load_dwordx4 v31, s[28:31], s52 offen lds
    s_add_u32 m0, s46, 25600
    s_add_u32 s52, s47, 207872
    buffer_load_dwordx4 v31, s[28:31], s52 offen lds
    s_add_u32 m0, s46, 26624
    s_add_u32 s52, s47, 215040
    buffer_load_dwordx4 v31, s[28:31], s52 offen lds
    s_add_u32 m0, s46, 27648
    s_add_u32 s52, s47, 222208
    buffer_load_dwordx4 v31, s[28:31], s52 offen lds
    s_add_u32 m0, s46, 28672
    s_add_u32 s52, s69, 7168
    buffer_load_dwordx4 v2, s[20:23], s52 offen lds
    s_add_u32 m0, s46, 29696
    s_add_u32 s52, s69, 64512
    buffer_load_dwordx4 v2, s[20:23], s52 offen lds
    s_add_u32 m0, s46, 30720
    s_add_u32 s52, s69, 121856
    buffer_load_dwordx4 v2, s[20:23], s52 offen lds
    s_add_u32 m0, s46, 31744
    s_add_u32 s52, s69, 179200
    buffer_load_dwordx4 v2, s[20:23], s52 offen lds
    v_mfma_f32_16x16x32_bf16 v[128:131], v[32:35], v[64:67], v[128:131]
    ds_read_b128 v[80:83], v10 offset:12288
    v_mfma_f32_16x16x32_bf16 v[132:135], v[32:35], v[68:71], v[132:135]
    ds_read_b128 v[84:87], v10 offset:13312
    v_mfma_f32_16x16x32_bf16 v[136:139], v[32:35], v[72:75], v[136:139]
    ds_read_b128 v[88:91], v10 offset:14336
    v_mfma_f32_16x16x32_bf16 v[140:143], v[32:35], v[76:79], v[140:143]
    ds_read_b128 v[92:95], v10 offset:15360
    v_mfma_f32_16x16x32_bf16 v[144:147], v[36:39], v[64:67], v[144:147]
    ds_read_b64_tr_b16 v[48:49], v3 offset:8192
    v_mfma_f32_16x16x32_bf16 v[148:151], v[36:39], v[68:71], v[148:151]
    ds_read_b64_tr_b16 v[50:51], v3 offset:10240
    v_mfma_f32_16x16x32_bf16 v[152:155], v[36:39], v[72:75], v[152:155]
    ds_read_b64_tr_b16 v[52:53], v4 offset:8192
    v_mfma_f32_16x16x32_bf16 v[156:159], v[36:39], v[76:79], v[156:159]
    ds_read_b64_tr_b16 v[54:55], v4 offset:10240
    v_mfma_f32_16x16x32_bf16 v[160:163], v[40:43], v[64:67], v[160:163]
    ds_read_b64_tr_b16 v[56:57], v5 offset:8192
    v_mfma_f32_16x16x32_bf16 v[164:167], v[40:43], v[68:71], v[164:167]
    ds_read_b64_tr_b16 v[58:59], v5 offset:10240
    v_mfma_f32_16x16x32_bf16 v[168:171], v[40:43], v[72:75], v[168:171]
    ds_read_b64_tr_b16 v[60:61], v6 offset:8192
    v_mfma_f32_16x16x32_bf16 v[172:175], v[40:43], v[76:79], v[172:175]
    ds_read_b64_tr_b16 v[62:63], v6 offset:10240
    v_mfma_f32_16x16x32_bf16 v[176:179], v[44:47], v[64:67], v[176:179]
    v_mfma_f32_16x16x32_bf16 v[180:183], v[44:47], v[68:71], v[180:183]
    v_mfma_f32_16x16x32_bf16 v[184:187], v[44:47], v[72:75], v[184:187]
    v_mfma_f32_16x16x32_bf16 v[188:191], v[44:47], v[76:79], v[188:191]
    s_waitcnt vmcnt(8) lgkmcnt(0)
    s_add_u32 m0, s46, 0
    s_add_u32 s52, s47, 229376
    buffer_load_dwordx4 v31, s[28:31], s52 offen lds
    s_add_u32 m0, s46, 1024
    s_add_u32 s52, s47, 236544
    buffer_load_dwordx4 v31, s[28:31], s52 offen lds
    s_add_u32 m0, s46, 2048
    s_add_u32 s52, s47, 243712
    buffer_load_dwordx4 v31, s[28:31], s52 offen lds
    s_add_u32 m0, s46, 3072
    s_add_u32 s52, s47, 250880
    buffer_load_dwordx4 v31, s[28:31], s52 offen lds
    s_add_u32 m0, s46, 4096
    s_add_u32 s52, s69, 8192
    buffer_load_dwordx4 v2, s[20:23], s52 offen lds
    s_add_u32 m0, s46, 5120
    s_add_u32 s52, s69, 65536
    buffer_load_dwordx4 v2, s[20:23], s52 offen lds
    s_add_u32 m0, s46, 6144
    s_add_u32 s52, s69, 122880
    buffer_load_dwordx4 v2, s[20:23], s52 offen lds
    s_add_u32 m0, s46, 7168
    s_add_u32 s52, s69, 180224
    buffer_load_dwordx4 v2, s[20:23], s52 offen lds
    v_mfma_f32_16x16x32_bf16 v[128:131], v[48:51], v[80:83], v[128:131]
    ds_read_b128 v[64:67], v10 offset:20480
    v_mfma_f32_16x16x32_bf16 v[132:135], v[48:51], v[84:87], v[132:135]
    ds_read_b128 v[68:71], v10 offset:21504
    v_mfma_f32_16x16x32_bf16 v[136:139], v[48:51], v[88:91], v[136:139]
    ds_read_b128 v[72:75], v10 offset:22528
    v_mfma_f32_16x16x32_bf16 v[140:143], v[48:51], v[92:95], v[140:143]
    ds_read_b128 v[76:79], v10 offset:23552
    v_mfma_f32_16x16x32_bf16 v[144:147], v[52:55], v[80:83], v[144:147]
    ds_read_b64_tr_b16 v[32:33], v3 offset:16384
    v_mfma_f32_16x16x32_bf16 v[148:151], v[52:55], v[84:87], v[148:151]
    ds_read_b64_tr_b16 v[34:35], v3 offset:18432
    v_mfma_f32_16x16x32_bf16 v[152:155], v[52:55], v[88:91], v[152:155]
    ds_read_b64_tr_b16 v[36:37], v4 offset:16384
    v_mfma_f32_16x16x32_bf16 v[156:159], v[52:55], v[92:95], v[156:159]
    ds_read_b64_tr_b16 v[38:39], v4 offset:18432
    v_mfma_f32_16x16x32_bf16 v[160:163], v[56:59], v[80:83], v[160:163]
    ds_read_b64_tr_b16 v[40:41], v5 offset:16384
    v_mfma_f32_16x16x32_bf16 v[164:167], v[56:59], v[84:87], v[164:167]
    ds_read_b64_tr_b16 v[42:43], v5 offset:18432
    v_mfma_f32_16x16x32_bf16 v[168:171], v[56:59], v[88:91], v[168:171]
    ds_read_b64_tr_b16 v[44:45], v6 offset:16384
    v_mfma_f32_16x16x32_bf16 v[172:175], v[56:59], v[92:95], v[172:175]
    ds_read_b64_tr_b16 v[46:47], v6 offset:18432
    v_mfma_f32_16x16x32_bf16 v[176:179], v[60:63], v[80:83], v[176:179]
    v_mfma_f32_16x16x32_bf16 v[180:183], v[60:63], v[84:87], v[180:183]
    v_mfma_f32_16x16x32_bf16 v[184:187], v[60:63], v[88:91], v[184:187]
    v_mfma_f32_16x16x32_bf16 v[188:191], v[60:63], v[92:95], v[188:191]
    s_waitcnt vmcnt(8) lgkmcnt(0)
    s_add_u32 m0, s46, 8192
    s_add_u32 s52, s47, 258048
    buffer_load_dwordx4 v31, s[28:31], s52 offen lds
    s_add_u32 m0, s46, 9216
    s_add_u32 s52, s47, 265216
    buffer_load_dwordx4 v31, s[28:31], s52 offen lds
    s_add_u32 m0, s46, 10240
    s_add_u32 s52, s47, 272384
    buffer_load_dwordx4 v31, s[28:31], s52 offen lds
    s_add_u32 m0, s46, 11264
    s_add_u32 s52, s47, 279552
    buffer_load_dwordx4 v31, s[28:31], s52 offen lds
    s_add_u32 m0, s46, 12288
    s_add_u32 s52, s69, 9216
    buffer_load_dwordx4 v2, s[20:23], s52 offen lds
    s_add_u32 m0, s46, 13312
    s_add_u32 s52, s69, 66560
    buffer_load_dwordx4 v2, s[20:23], s52 offen lds
    s_add_u32 m0, s46, 14336
    s_add_u32 s52, s69, 123904
    buffer_load_dwordx4 v2, s[20:23], s52 offen lds
    s_add_u32 m0, s46, 15360
    s_add_u32 s52, s69, 181248
    buffer_load_dwordx4 v2, s[20:23], s52 offen lds
    v_mfma_f32_16x16x32_bf16 v[128:131], v[32:35], v[64:67], v[128:131]
    ds_read_b128 v[80:83], v10 offset:28672
    v_mfma_f32_16x16x32_bf16 v[132:135], v[32:35], v[68:71], v[132:135]
    ds_read_b128 v[84:87], v10 offset:29696
    v_mfma_f32_16x16x32_bf16 v[136:139], v[32:35], v[72:75], v[136:139]
    ds_read_b128 v[88:91], v10 offset:30720
    v_mfma_f32_16x16x32_bf16 v[140:143], v[32:35], v[76:79], v[140:143]
    ds_read_b128 v[92:95], v10 offset:31744
    v_mfma_f32_16x16x32_bf16 v[144:147], v[36:39], v[64:67], v[144:147]
    ds_read_b64_tr_b16 v[48:49], v3 offset:24576
    v_mfma_f32_16x16x32_bf16 v[148:151], v[36:39], v[68:71], v[148:151]
    ds_read_b64_tr_b16 v[50:51], v3 offset:26624
    v_mfma_f32_16x16x32_bf16 v[152:155], v[36:39], v[72:75], v[152:155]
    ds_read_b64_tr_b16 v[52:53], v4 offset:24576
    v_mfma_f32_16x16x32_bf16 v[156:159], v[36:39], v[76:79], v[156:159]
    ds_read_b64_tr_b16 v[54:55], v4 offset:26624
    v_mfma_f32_16x16x32_bf16 v[160:163], v[40:43], v[64:67], v[160:163]
    ds_read_b64_tr_b16 v[56:57], v5 offset:24576
    v_mfma_f32_16x16x32_bf16 v[164:167], v[40:43], v[68:71], v[164:167]
    ds_read_b64_tr_b16 v[58:59], v5 offset:26624
    v_mfma_f32_16x16x32_bf16 v[168:171], v[40:43], v[72:75], v[168:171]
    ds_read_b64_tr_b16 v[60:61], v6 offset:24576
    v_mfma_f32_16x16x32_bf16 v[172:175], v[40:43], v[76:79], v[172:175]
    ds_read_b64_tr_b16 v[62:63], v6 offset:26624
    v_mfma_f32_16x16x32_bf16 v[176:179], v[44:47], v[64:67], v[176:179]
    v_mfma_f32_16x16x32_bf16 v[180:183], v[44:47], v[68:71], v[180:183]
    v_mfma_f32_16x16x32_bf16 v[184:187], v[44:47], v[72:75], v[184:187]
    v_mfma_f32_16x16x32_bf16 v[188:191], v[44:47], v[76:79], v[188:191]
    s_waitcnt vmcnt(8) lgkmcnt(0)
    s_add_u32 m0, s46, 16384
    s_add_u32 s52, s47, 286720
    buffer_load_dwordx4 v31, s[28:31], s52 offen lds
    s_add_u32 m0, s46, 17408
    s_add_u32 s52, s47, 293888
    buffer_load_dwordx4 v31, s[28:31], s52 offen lds
    s_add_u32 m0, s46, 18432
    s_add_u32 s52, s47, 301056
    buffer_load_dwordx4 v31, s[28:31], s52 offen lds
    s_add_u32 m0, s46, 19456
    s_add_u32 s52, s47, 308224
    buffer_load_dwordx4 v31, s[28:31], s52 offen lds
    s_add_u32 m0, s46, 20480
    s_add_u32 s52, s69, 10240
    buffer_load_dwordx4 v2, s[20:23], s52 offen lds
    s_add_u32 m0, s46, 21504
    s_add_u32 s52, s69, 67584
    buffer_load_dwordx4 v2, s[20:23], s52 offen lds
    s_add_u32 m0, s46, 22528
    s_add_u32 s52, s69, 124928
    buffer_load_dwordx4 v2, s[20:23], s52 offen lds
    s_add_u32 m0, s46, 23552
    s_add_u32 s52, s69, 182272
    buffer_load_dwordx4 v2, s[20:23], s52 offen lds
    v_mfma_f32_16x16x32_bf16 v[128:131], v[48:51], v[80:83], v[128:131]
    ds_read_b128 v[64:67], v10 offset:4096
    v_mfma_f32_16x16x32_bf16 v[132:135], v[48:51], v[84:87], v[132:135]
    ds_read_b128 v[68:71], v10 offset:5120
    v_mfma_f32_16x16x32_bf16 v[136:139], v[48:51], v[88:91], v[136:139]
    ds_read_b128 v[72:75], v10 offset:6144
    v_mfma_f32_16x16x32_bf16 v[140:143], v[48:51], v[92:95], v[140:143]
    ds_read_b128 v[76:79], v10 offset:7168
    v_mfma_f32_16x16x32_bf16 v[144:147], v[52:55], v[80:83], v[144:147]
    ds_read_b64_tr_b16 v[32:33], v3 offset:0
    v_mfma_f32_16x16x32_bf16 v[148:151], v[52:55], v[84:87], v[148:151]
    ds_read_b64_tr_b16 v[34:35], v3 offset:2048
    v_mfma_f32_16x16x32_bf16 v[152:155], v[52:55], v[88:91], v[152:155]
    ds_read_b64_tr_b16 v[36:37], v4 offset:0
    v_mfma_f32_16x16x32_bf16 v[156:159], v[52:55], v[92:95], v[156:159]
    ds_read_b64_tr_b16 v[38:39], v4 offset:2048
    v_mfma_f32_16x16x32_bf16 v[160:163], v[56:59], v[80:83], v[160:163]
    ds_read_b64_tr_b16 v[40:41], v5 offset:0
    v_mfma_f32_16x16x32_bf16 v[164:167], v[56:59], v[84:87], v[164:167]
    ds_read_b64_tr_b16 v[42:43], v5 offset:2048
    v_mfma_f32_16x16x32_bf16 v[168:171], v[56:59], v[88:91], v[168:171]
    ds_read_b64_tr_b16 v[44:45], v6 offset:0
    v_mfma_f32_16x16x32_bf16 v[172:175], v[56:59], v[92:95], v[172:175]
    ds_read_b64_tr_b16 v[46:47], v6 offset:2048
    v_mfma_f32_16x16x32_bf16 v[176:179], v[60:63], v[80:83], v[176:179]
    v_mfma_f32_16x16x32_bf16 v[180:183], v[60:63], v[84:87], v[180:183]
    v_mfma_f32_16x16x32_bf16 v[184:187], v[60:63], v[88:91], v[184:187]
    v_mfma_f32_16x16x32_bf16 v[188:191], v[60:63], v[92:95], v[188:191]
    s_waitcnt vmcnt(8) lgkmcnt(0)
    s_add_u32 m0, s46, 24576
    s_add_u32 s52, s47, 315392
    buffer_load_dwordx4 v31, s[28:31], s52 offen lds
    s_add_u32 m0, s46, 25600
    s_add_u32 s52, s47, 322560
    buffer_load_dwordx4 v31, s[28:31], s52 offen lds
    s_add_u32 m0, s46, 26624
    s_add_u32 s52, s47, 329728
    buffer_load_dwordx4 v31, s[28:31], s52 offen lds
    s_add_u32 m0, s46, 27648
    s_add_u32 s52, s47, 336896
    buffer_load_dwordx4 v31, s[28:31], s52 offen lds
    s_add_u32 m0, s46, 28672
    s_add_u32 s52, s69, 11264
    buffer_load_dwordx4 v2, s[20:23], s52 offen lds
    s_add_u32 m0, s46, 29696
    s_add_u32 s52, s69, 68608
    buffer_load_dwordx4 v2, s[20:23], s52 offen lds
    s_add_u32 m0, s46, 30720
    s_add_u32 s52, s69, 125952
    buffer_load_dwordx4 v2, s[20:23], s52 offen lds
    s_add_u32 m0, s46, 31744
    s_add_u32 s52, s69, 183296
    buffer_load_dwordx4 v2, s[20:23], s52 offen lds
    v_mfma_f32_16x16x32_bf16 v[128:131], v[32:35], v[64:67], v[128:131]
    ds_read_b128 v[80:83], v10 offset:12288
    v_mfma_f32_16x16x32_bf16 v[132:135], v[32:35], v[68:71], v[132:135]
    ds_read_b128 v[84:87], v10 offset:13312
    v_mfma_f32_16x16x32_bf16 v[136:139], v[32:35], v[72:75], v[136:139]
    ds_read_b128 v[88:91], v10 offset:14336
    v_mfma_f32_16x16x32_bf16 v[140:143], v[32:35], v[76:79], v[140:143]
    ds_read_b128 v[92:95], v10 offset:15360
    v_mfma_f32_16x16x32_bf16 v[144:147], v[36:39], v[64:67], v[144:147]
    ds_read_b64_tr_b16 v[48:49], v3 offset:8192
    v_mfma_f32_16x16x32_bf16 v[148:151], v[36:39], v[68:71], v[148:151]
    ds_read_b64_tr_b16 v[50:51], v3 offset:10240
    v_mfma_f32_16x16x32_bf16 v[152:155], v[36:39], v[72:75], v[152:155]
    ds_read_b64_tr_b16 v[52:53], v4 offset:8192
    v_mfma_f32_16x16x32_bf16 v[156:159], v[36:39], v[76:79], v[156:159]
    ds_read_b64_tr_b16 v[54:55], v4 offset:10240
    v_mfma_f32_16x16x32_bf16 v[160:163], v[40:43], v[64:67], v[160:163]
    ds_read_b64_tr_b16 v[56:57], v5 offset:8192
    v_mfma_f32_16x16x32_bf16 v[164:167], v[40:43], v[68:71], v[164:167]
    ds_read_b64_tr_b16 v[58:59], v5 offset:10240
    v_mfma_f32_16x16x32_bf16 v[168:171], v[40:43], v[72:75], v[168:171]
    ds_read_b64_tr_b16 v[60:61], v6 offset:8192
    v_mfma_f32_16x16x32_bf16 v[172:175], v[40:43], v[76:79], v[172:175]
    ds_read_b64_tr_b16 v[62:63], v6 offset:10240
    v_mfma_f32_16x16x32_bf16 v[176:179], v[44:47], v[64:67], v[176:179]
    v_mfma_f32_16x16x32_bf16 v[180:183], v[44:47], v[68:71], v[180:183]
    v_mfma_f32_16x16x32_bf16 v[184:187], v[44:47], v[72:75], v[184:187]
    v_mfma_f32_16x16x32_bf16 v[188:191], v[44:47], v[76:79], v[188:191]
    s_waitcnt vmcnt(8) lgkmcnt(0)
    s_add_u32 m0, s46, 0
    s_add_u32 s52, s47, 344064
    buffer_load_dwordx4 v31, s[28:31], s52 offen lds
    s_add_u32 m0, s46, 1024
    s_add_u32 s52, s47, 351232
    buffer_load_dwordx4 v31, s[28:31], s52 offen lds
    s_add_u32 m0, s46, 2048
    s_add_u32 s52, s47, 358400
    buffer_load_dwordx4 v31, s[28:31], s52 offen lds
    s_add_u32 m0, s46, 3072
    s_add_u32 s52, s47, 365568
    buffer_load_dwordx4 v31, s[28:31], s52 offen lds
    s_add_u32 m0, s46, 4096
    s_add_u32 s52, s69, 12288
    buffer_load_dwordx4 v2, s[20:23], s52 offen lds
    s_add_u32 m0, s46, 5120
    s_add_u32 s52, s69, 69632
    buffer_load_dwordx4 v2, s[20:23], s52 offen lds
    s_add_u32 m0, s46, 6144
    s_add_u32 s52, s69, 126976
    buffer_load_dwordx4 v2, s[20:23], s52 offen lds
    s_add_u32 m0, s46, 7168
    s_add_u32 s52, s69, 184320
    buffer_load_dwordx4 v2, s[20:23], s52 offen lds
    v_mov_b32 v13, 0
    buffer_load_dword v7, v13, s[40:43], 0 offen sc1
    v_and_b32 v12, 15, v1
    v_lshlrev_b32 v12, 2, v12
    s_lshl_b32 s52, s44, 8
    s_lshl_b32 s53, s50, 6
    s_add_u32 s52, s52, s53
    s_add_u32 s52, s52, 11599872
    buffer_load_dword v9, v12, s[20:23], s52 offen
    v_mfma_f32_16x16x32_bf16 v[128:131], v[48:51], v[80:83], v[128:131]
    ds_read_b128 v[64:67], v10 offset:20480
    v_mfma_f32_16x16x32_bf16 v[132:135], v[48:51], v[84:87], v[132:135]
    ds_read_b128 v[68:71], v10 offset:21504
    v_mfma_f32_16x16x32_bf16 v[136:139], v[48:51], v[88:91], v[136:139]
    ds_read_b128 v[72:75], v10 offset:22528
    v_mfma_f32_16x16x32_bf16 v[140:143], v[48:51], v[92:95], v[140:143]
    ds_read_b128 v[76:79], v10 offset:23552
    v_mfma_f32_16x16x32_bf16 v[144:147], v[52:55], v[80:83], v[144:147]
    ds_read_b64_tr_b16 v[32:33], v3 offset:16384
    v_mfma_f32_16x16x32_bf16 v[148:151], v[52:55], v[84:87], v[148:151]
    ds_read_b64_tr_b16 v[34:35], v3 offset:18432
    v_mfma_f32_16x16x32_bf16 v[152:155], v[52:55], v[88:91], v[152:155]
    ds_read_b64_tr_b16 v[36:37], v4 offset:16384
    v_mfma_f32_16x16x32_bf16 v[156:159], v[52:55], v[92:95], v[156:159]
    ds_read_b64_tr_b16 v[38:39], v4 offset:18432
    v_mfma_f32_16x16x32_bf16 v[160:163], v[56:59], v[80:83], v[160:163]
    ds_read_b64_tr_b16 v[40:41], v5 offset:16384
    v_mfma_f32_16x16x32_bf16 v[164:167], v[56:59], v[84:87], v[164:167]
    ds_read_b64_tr_b16 v[42:43], v5 offset:18432
    v_mfma_f32_16x16x32_bf16 v[168:171], v[56:59], v[88:91], v[168:171]
    ds_read_b64_tr_b16 v[44:45], v6 offset:16384
    v_mfma_f32_16x16x32_bf16 v[172:175], v[56:59], v[92:95], v[172:175]
    ds_read_b64_tr_b16 v[46:47], v6 offset:18432
    v_mfma_f32_16x16x32_bf16 v[176:179], v[60:63], v[80:83], v[176:179]
    v_mfma_f32_16x16x32_bf16 v[180:183], v[60:63], v[84:87], v[180:183]
    v_mfma_f32_16x16x32_bf16 v[184:187], v[60:63], v[88:91], v[184:187]
    v_mfma_f32_16x16x32_bf16 v[188:191], v[60:63], v[92:95], v[188:191]
    s_waitcnt vmcnt(10) lgkmcnt(0)
    s_add_u32 m0, s46, 8192
    s_add_u32 s52, s47, 372736
    buffer_load_dwordx4 v31, s[28:31], s52 offen lds
    s_add_u32 m0, s46, 9216
    s_add_u32 s52, s47, 379904
    buffer_load_dwordx4 v31, s[28:31], s52 offen lds
    s_add_u32 m0, s46, 10240
    s_add_u32 s52, s47, 387072
    buffer_load_dwordx4 v31, s[28:31], s52 offen lds
    s_add_u32 m0, s46, 11264
    s_add_u32 s52, s47, 394240
    buffer_load_dwordx4 v31, s[28:31], s52 offen lds
    s_add_u32 m0, s46, 12288
    s_add_u32 s52, s69, 13312
    buffer_load_dwordx4 v2, s[20:23], s52 offen lds
    s_add_u32 m0, s46, 13312
    s_add_u32 s52, s69, 70656
    buffer_load_dwordx4 v2, s[20:23], s52 offen lds
    s_add_u32 m0, s46, 14336
    s_add_u32 s52, s69, 128000
    buffer_load_dwordx4 v2, s[20:23], s52 offen lds
    s_add_u32 m0, s46, 15360
    s_add_u32 s52, s69, 185344
    buffer_load_dwordx4 v2, s[20:23], s52 offen lds
    v_mfma_f32_16x16x32_bf16 v[128:131], v[32:35], v[64:67], v[128:131]
    ds_read_b128 v[80:83], v10 offset:28672
    v_mfma_f32_16x16x32_bf16 v[132:135], v[32:35], v[68:71], v[132:135]
    ds_read_b128 v[84:87], v10 offset:29696
    v_mfma_f32_16x16x32_bf16 v[136:139], v[32:35], v[72:75], v[136:139]
    ds_read_b128 v[88:91], v10 offset:30720
    v_mfma_f32_16x16x32_bf16 v[140:143], v[32:35], v[76:79], v[140:143]
    ds_read_b128 v[92:95], v10 offset:31744
    v_mfma_f32_16x16x32_bf16 v[144:147], v[36:39], v[64:67], v[144:147]
    ds_read_b64_tr_b16 v[48:49], v3 offset:24576
    v_mfma_f32_16x16x32_bf16 v[148:151], v[36:39], v[68:71], v[148:151]
    ds_read_b64_tr_b16 v[50:51], v3 offset:26624
    v_mfma_f32_16x16x32_bf16 v[152:155], v[36:39], v[72:75], v[152:155]
    ds_read_b64_tr_b16 v[52:53], v4 offset:24576
    v_mfma_f32_16x16x32_bf16 v[156:159], v[36:39], v[76:79], v[156:159]
    ds_read_b64_tr_b16 v[54:55], v4 offset:26624
    v_mfma_f32_16x16x32_bf16 v[160:163], v[40:43], v[64:67], v[160:163]
    ds_read_b64_tr_b16 v[56:57], v5 offset:24576
    v_mfma_f32_16x16x32_bf16 v[164:167], v[40:43], v[68:71], v[164:167]
    ds_read_b64_tr_b16 v[58:59], v5 offset:26624
    v_mfma_f32_16x16x32_bf16 v[168:171], v[40:43], v[72:75], v[168:171]
    ds_read_b64_tr_b16 v[60:61], v6 offset:24576
    v_mfma_f32_16x16x32_bf16 v[172:175], v[40:43], v[76:79], v[172:175]
    ds_read_b64_tr_b16 v[62:63], v6 offset:26624
    v_mfma_f32_16x16x32_bf16 v[176:179], v[44:47], v[64:67], v[176:179]
    v_mfma_f32_16x16x32_bf16 v[180:183], v[44:47], v[68:71], v[180:183]
    v_mfma_f32_16x16x32_bf16 v[184:187], v[44:47], v[72:75], v[184:187]
    v_mfma_f32_16x16x32_bf16 v[188:191], v[44:47], v[76:79], v[188:191]
    s_waitcnt vmcnt(10) lgkmcnt(0)
    s_add_u32 m0, s46, 16384
    s_add_u32 s52, s68, 0
    buffer_load_dwordx4 v31, s[32:35], s52 offen lds
    s_add_u32 m0, s46, 17408
    s_add_u32 s52, s68, 7168
    buffer_load_dwordx4 v31, s[32:35], s52 offen lds
    s_add_u32 m0, s46, 18432
    s_add_u32 s52, s68, 14336
    buffer_load_dwordx4 v31, s[32:35], s52 offen lds
    s_add_u32 m0, s46, 19456
    s_add_u32 s52, s68, 21504
    buffer_load_dwordx4 v31, s[32:35], s52 offen lds
    s_add_u32 m0, s46, 20480
    s_add_u32 s52, s70, 0
    buffer_load_dwordx4 v2, s[20:23], s52 offen lds
    s_add_u32 m0, s46, 21504
    s_add_u32 s52, s70, 16384
    buffer_load_dwordx4 v2, s[20:23], s52 offen lds
    s_add_u32 m0, s46, 22528
    s_add_u32 s52, s70, 32768
    buffer_load_dwordx4 v2, s[20:23], s52 offen lds
    s_add_u32 m0, s46, 23552
    s_add_u32 s52, s70, 49152
    buffer_load_dwordx4 v2, s[20:23], s52 offen lds
    v_mfma_f32_16x16x32_bf16 v[128:131], v[48:51], v[80:83], v[128:131]
    ds_read_b128 v[64:67], v10 offset:4096
    v_mfma_f32_16x16x32_bf16 v[132:135], v[48:51], v[84:87], v[132:135]
    ds_read_b128 v[68:71], v10 offset:5120
    v_mfma_f32_16x16x32_bf16 v[136:139], v[48:51], v[88:91], v[136:139]
    ds_read_b128 v[72:75], v10 offset:6144
    v_mfma_f32_16x16x32_bf16 v[140:143], v[48:51], v[92:95], v[140:143]
    ds_read_b128 v[76:79], v10 offset:7168
    v_mfma_f32_16x16x32_bf16 v[144:147], v[52:55], v[80:83], v[144:147]
    ds_read_b64_tr_b16 v[32:33], v3 offset:0
    v_mfma_f32_16x16x32_bf16 v[148:151], v[52:55], v[84:87], v[148:151]
    ds_read_b64_tr_b16 v[34:35], v3 offset:2048
    v_mfma_f32_16x16x32_bf16 v[152:155], v[52:55], v[88:91], v[152:155]
    ds_read_b64_tr_b16 v[36:37], v4 offset:0
    v_mfma_f32_16x16x32_bf16 v[156:159], v[52:55], v[92:95], v[156:159]
    ds_read_b64_tr_b16 v[38:39], v4 offset:2048
    v_mfma_f32_16x16x32_bf16 v[160:163], v[56:59], v[80:83], v[160:163]
    ds_read_b64_tr_b16 v[40:41], v5 offset:0
    v_mfma_f32_16x16x32_bf16 v[164:167], v[56:59], v[84:87], v[164:167]
    ds_read_b64_tr_b16 v[42:43], v5 offset:2048
    v_mfma_f32_16x16x32_bf16 v[168:171], v[56:59], v[88:91], v[168:171]
    ds_read_b64_tr_b16 v[44:45], v6 offset:0
    v_mfma_f32_16x16x32_bf16 v[172:175], v[56:59], v[92:95], v[172:175]
    ds_read_b64_tr_b16 v[46:47], v6 offset:2048
    v_mfma_f32_16x16x32_bf16 v[176:179], v[60:63], v[80:83], v[176:179]
    v_mfma_f32_16x16x32_bf16 v[180:183], v[60:63], v[84:87], v[180:183]
    v_mfma_f32_16x16x32_bf16 v[184:187], v[60:63], v[88:91], v[184:187]
    v_mfma_f32_16x16x32_bf16 v[188:191], v[60:63], v[92:95], v[188:191]
    s_waitcnt vmcnt(8) lgkmcnt(0)
    s_add_u32 m0, s46, 24576
    s_add_u32 s52, s68, 25088
    buffer_load_dwordx4 v31, s[32:35], s52 offen lds
    s_add_u32 m0, s46, 25600
    s_add_u32 s52, s68, 32256
    buffer_load_dwordx4 v31, s[32:35], s52 offen lds
    s_add_u32 m0, s46, 26624
    s_add_u32 s52, s68, 39424
    buffer_load_dwordx4 v31, s[32:35], s52 offen lds
    s_add_u32 m0, s46, 27648
    s_add_u32 s52, s68, 46592
    buffer_load_dwordx4 v31, s[32:35], s52 offen lds
    s_add_u32 m0, s46, 28672
    s_add_u32 s52, s70, 1024
    buffer_load_dwordx4 v2, s[20:23], s52 offen lds
    s_add_u32 m0, s46, 29696
    s_add_u32 s52, s70, 17408
    buffer_load_dwordx4 v2, s[20:23], s52 offen lds
    s_add_u32 m0, s46, 30720
    s_add_u32 s52, s70, 33792
    buffer_load_dwordx4 v2, s[20:23], s52 offen lds
    s_add_u32 m0, s46, 31744
    s_add_u32 s52, s70, 50176
    buffer_load_dwordx4 v2, s[20:23], s52 offen lds
K2_CHK:
    v_readfirstlane_b32 s54, v7
    s_cmp_ge_u32 s54, 16
    s_cbranch_scc1 K2_KVOK
    s_sleep 8
    buffer_load_dword v7, v13, s[40:43], 0 offen sc1
    s_waitcnt vmcnt(0)
    s_branch K2_CHK
K2_KVOK:
    s_add_u32 s52, s71, 0
    buffer_load_dwordx4 v[96:99], v2, s[20:23], s52 offen sc1
    buffer_load_dwordx4 v[100:103], v2, s[20:23], s52 offen offset:1024 sc1
    buffer_load_dwordx4 v[104:107], v8, s[20:23], s52 offen sc1
    s_add_u32 s52, s71, 2048
    buffer_load_dwordx4 v[108:111], v2, s[20:23], s52 offen sc1
    buffer_load_dwordx4 v[112:115], v2, s[20:23], s52 offen offset:1024 sc1
    buffer_load_dwordx4 v[116:119], v8, s[20:23], s52 offen sc1
    v_mfma_f32_16x16x32_bf16 v[128:131], v[32:35], v[64:67], v[128:131]
    ds_read_b128 v[80:83], v10 offset:12288
    v_mfma_f32_16x16x32_bf16 v[132:135], v[32:35], v[68:71], v[132:135]
    ds_read_b128 v[84:87], v10 offset:13312
    v_mfma_f32_16x16x32_bf16 v[136:139], v[32:35], v[72:75], v[136:139]
    ds_read_b128 v[88:91], v10 offset:14336
    v_mfma_f32_16x16x32_bf16 v[140:143], v[32:35], v[76:79], v[140:143]
    ds_read_b128 v[92:95], v10 offset:15360
    v_mfma_f32_16x16x32_bf16 v[144:147], v[36:39], v[64:67], v[144:147]
    ds_read_b64_tr_b16 v[48:49], v3 offset:8192
    v_mfma_f32_16x16x32_bf16 v[148:151], v[36:39], v[68:71], v[148:151]
    ds_read_b64_tr_b16 v[50:51], v3 offset:10240
    v_mfma_f32_16x16x32_bf16 v[152:155], v[36:39], v[72:75], v[152:155]
    ds_read_b64_tr_b16 v[52:53], v4 offset:8192
    v_mfma_f32_16x16x32_bf16 v[156:159], v[36:39], v[76:79], v[156:159]
    ds_read_b64_tr_b16 v[54:55], v4 offset:10240
    v_mfma_f32_16x16x32_bf16 v[160:163], v[40:43], v[64:67], v[160:163]
    ds_read_b64_tr_b16 v[56:57], v5 offset:8192
    v_mfma_f32_16x16x32_bf16 v[164:167], v[40:43], v[68:71], v[164:167]
    ds_read_b64_tr_b16 v[58:59], v5 offset:10240
    v_mfma_f32_16x16x32_bf16 v[168:171], v[40:43], v[72:75], v[168:171]
    ds_read_b64_tr_b16 v[60:61], v6 offset:8192
    v_mfma_f32_16x16x32_bf16 v[172:175], v[40:43], v[76:79], v[172:175]
    ds_read_b64_tr_b16 v[62:63], v6 offset:10240
    v_mfma_f32_16x16x32_bf16 v[176:179], v[44:47], v[64:67], v[176:179]
    v_mfma_f32_16x16x32_bf16 v[180:183], v[44:47], v[68:71], v[180:183]
    v_mfma_f32_16x16x32_bf16 v[184:187], v[44:47], v[72:75], v[184:187]
    v_mfma_f32_16x16x32_bf16 v[188:191], v[44:47], v[76:79], v[188:191]
    s_waitcnt vmcnt(14) lgkmcnt(0)
    s_add_u32 m0, s46, 0
    s_add_u32 s52, s68, 50176
    buffer_load_dwordx4 v31, s[32:35], s52 offen lds
    s_add_u32 m0, s46, 1024
    s_add_u32 s52, s68, 57344
    buffer_load_dwordx4 v31, s[32:35], s52 offen lds
    s_add_u32 m0, s46, 2048
    s_add_u32 s52, s68, 64512
    buffer_load_dwordx4 v31, s[32:35], s52 offen lds
    s_add_u32 m0, s46, 3072
    s_add_u32 s52, s68, 71680
    buffer_load_dwordx4 v31, s[32:35], s52 offen lds
    s_add_u32 m0, s46, 4096
    s_add_u32 s52, s70, 2048
    buffer_load_dwordx4 v2, s[20:23], s52 offen lds
    s_add_u32 m0, s46, 5120
    s_add_u32 s52, s70, 18432
    buffer_load_dwordx4 v2, s[20:23], s52 offen lds
    s_add_u32 m0, s46, 6144
    s_add_u32 s52, s70, 34816
    buffer_load_dwordx4 v2, s[20:23], s52 offen lds
    s_add_u32 m0, s46, 7168
    s_add_u32 s52, s70, 51200
    buffer_load_dwordx4 v2, s[20:23], s52 offen lds
    v_mfma_f32_16x16x32_bf16 v[128:131], v[48:51], v[80:83], v[128:131]
    ds_read_b128 v[64:67], v10 offset:20480
    v_mfma_f32_16x16x32_bf16 v[132:135], v[48:51], v[84:87], v[132:135]
    ds_read_b128 v[68:71], v10 offset:21504
    v_mfma_f32_16x16x32_bf16 v[136:139], v[48:51], v[88:91], v[136:139]
    ds_read_b128 v[72:75], v10 offset:22528
    v_mfma_f32_16x16x32_bf16 v[140:143], v[48:51], v[92:95], v[140:143]
    ds_read_b128 v[76:79], v10 offset:23552
    v_mfma_f32_16x16x32_bf16 v[144:147], v[52:55], v[80:83], v[144:147]
    ds_read_b64_tr_b16 v[32:33], v3 offset:16384
    v_mfma_f32_16x16x32_bf16 v[148:151], v[52:55], v[84:87], v[148:151]
    ds_read_b64_tr_b16 v[34:35], v3 offset:18432
    v_mfma_f32_16x16x32_bf16 v[152:155], v[52:55], v[88:91], v[152:155]
    ds_read_b64_tr_b16 v[36:37], v4 offset:16384
    v_mfma_f32_16x16x32_bf16 v[156:159], v[52:55], v[92:95], v[156:159]
    ds_read_b64_tr_b16 v[38:39], v4 offset:18432
    v_mfma_f32_16x16x32_bf16 v[160:163], v[56:59], v[80:83], v[160:163]
    ds_read_b64_tr_b16 v[40:41], v5 offset:16384
    v_mfma_f32_16x16x32_bf16 v[164:167], v[56:59], v[84:87], v[164:167]
    ds_read_b64_tr_b16 v[42:43], v5 offset:18432
    v_mfma_f32_16x16x32_bf16 v[168:171], v[56:59], v[88:91], v[168:171]
    ds_read_b64_tr_b16 v[44:45], v6 offset:16384
    v_mfma_f32_16x16x32_bf16 v[172:175], v[56:59], v[92:95], v[172:175]
    ds_read_b64_tr_b16 v[46:47], v6 offset:18432
    v_mfma_f32_16x16x32_bf16 v[176:179], v[60:63], v[80:83], v[176:179]
    v_mfma_f32_16x16x32_bf16 v[180:183], v[60:63], v[84:87], v[180:183]
    v_mfma_f32_16x16x32_bf16 v[184:187], v[60:63], v[88:91], v[184:187]
    v_mfma_f32_16x16x32_bf16 v[188:191], v[60:63], v[92:95], v[188:191]
    s_waitcnt vmcnt(14) lgkmcnt(0)
    s_add_u32 m0, s46, 8192
    s_add_u32 s52, s68, 75264
    buffer_load_dwordx4 v31, s[32:35], s52 offen lds
    s_add_u32 m0, s46, 9216
    s_add_u32 s52, s68, 82432
    buffer_load_dwordx4 v31, s[32:35], s52 offen lds
    s_add_u32 m0, s46, 10240
    s_add_u32 s52, s68, 89600
    buffer_load_dwordx4 v31, s[32:35], s52 offen lds
    s_add_u32 m0, s46, 11264
    s_add_u32 s52, s68, 96768
    buffer_load_dwordx4 v31, s[32:35], s52 offen lds
    s_add_u32 m0, s46, 12288
    s_add_u32 s52, s70, 3072
    buffer_load_dwordx4 v2, s[20:23], s52 offen lds
    s_add_u32 m0, s46, 13312
    s_add_u32 s52, s70, 19456
    buffer_load_dwordx4 v2, s[20:23], s52 offen lds
    s_add_u32 m0, s46, 14336
    s_add_u32 s52, s70, 35840
    buffer_load_dwordx4 v2, s[20:23], s52 offen lds
    s_add_u32 m0, s46, 15360
    s_add_u32 s52, s70, 52224
    buffer_load_dwordx4 v2, s[20:23], s52 offen lds
    s_waitcnt vmcnt(19)
    v_cmp_gt_u32 vcc, 48, v1
    s_nop 1
    v_cndmask_b32 v7, 0, -1, vcc
    v_mfma_f32_16x16x32_bf16 v[12:15], v[96:99], v[64:67], 0
    ds_read_b128 v[80:83], v10 offset:28672
    v_mfma_f32_16x16x32_bf16 v[16:19], v[100:103], v[64:67], 0
    ds_read_b128 v[84:87], v10 offset:29696
    v_mfma_f32_16x16x32_bf16 v[20:23], v[96:99], v[68:71], 0
    ds_read_b128 v[88:91], v10 offset:30720
    v_mfma_f32_16x16x32_bf16 v[24:27], v[100:103], v[68:71], 0
    ds_read_b128 v[92:95], v10 offset:31744
    v_mfma_f32_16x16x32_bf16 v[120:123], v[104:107], v[64:67], 0
    ds_read_b64_tr_b16 v[48:49], v3 offset:24576
    v_mfma_f32_16x16x32_bf16 v[124:127], v[104:107], v[68:71], 0
    ds_read_b64_tr_b16 v[50:51], v3 offset:26624
    s_nop 7
    v_add_f32 v28, s67, v120
    v_add_f32 v29, s67, v124
    v_rcp_f32 v28, v28
    v_rcp_f32 v29, v29
    s_nop 0
    v_pk_mul_f32 v[12:13], v[12:13], v[28:29] op_sel:[0,0] op_sel_hi:[1,0]
    v_pk_mul_f32 v[14:15], v[14:15], v[28:29] op_sel:[0,0] op_sel_hi:[1,0]
    v_pk_mul_f32 v[16:17], v[16:17], v[28:29] op_sel:[0,0] op_sel_hi:[1,0]
    v_pk_mul_f32 v[18:19], v[18:19], v[28:29] op_sel:[0,0] op_sel_hi:[1,0]
    v_cvt_pk_bf16_f32 v120, v12, v13
    v_cvt_pk_bf16_f32 v121, v14, v15
    v_cvt_pk_bf16_f32 v122, v16, v17
    v_cvt_pk_bf16_f32 v123, v18, v19
    v_and_b32 v122, v122, v7
    v_and_b32 v123, v123, v7
    v_pk_mul_f32 v[20:21], v[20:21], v[28:29] op_sel:[0,1] op_sel_hi:[1,1]
    v_pk_mul_f32 v[22:23], v[22:23], v[28:29] op_sel:[0,1] op_sel_hi:[1,1]
    v_pk_mul_f32 v[24:25], v[24:25], v[28:29] op_sel:[0,1] op_sel_hi:[1,1]
    v_pk_mul_f32 v[26:27], v[26:27], v[28:29] op_sel:[0,1] op_sel_hi:[1,1]
    v_cvt_pk_bf16_f32 v124, v20, v21
    v_cvt_pk_bf16_f32 v125, v22, v23
    v_cvt_pk_bf16_f32 v126, v24, v25
    v_cvt_pk_bf16_f32 v127, v26, v27
    v_and_b32 v126, v126, v7
    v_and_b32 v127, v127, v7
    s_nop 1
    v_mfma_f32_16x16x32_bf16 v[192:195], v[32:35], v[120:123], 0
    v_mfma_f32_16x16x32_bf16 v[208:211], v[36:39], v[120:123], 0
    v_mfma_f32_16x16x32_bf16 v[224:227], v[40:43], v[120:123], 0
    v_mfma_f32_16x16x32_bf16 v[240:243], v[44:47], v[120:123], 0
    v_mfma_f32_16x16x32_bf16 v[196:199], v[32:35], v[124:127], 0
    v_mfma_f32_16x16x32_bf16 v[212:215], v[36:39], v[124:127], 0
    v_mfma_f32_16x16x32_bf16 v[228:231], v[40:43], v[124:127], 0
    v_mfma_f32_16x16x32_bf16 v[244:247], v[44:47], v[124:127], 0
    s_nop 3
    v_mfma_f32_16x16x32_bf16 v[12:15], v[96:99], v[72:75], 0
    ds_read_b64_tr_b16 v[52:53], v4 offset:24576
    v_mfma_f32_16x16x32_bf16 v[16:19], v[100:103], v[72:75], 0
    ds_read_b64_tr_b16 v[54:55], v4 offset:26624
    v_mfma_f32_16x16x32_bf16 v[20:23], v[96:99], v[76:79], 0
    ds_read_b64_tr_b16 v[56:57], v5 offset:24576
    v_mfma_f32_16x16x32_bf16 v[24:27], v[100:103], v[76:79], 0
    ds_read_b64_tr_b16 v[58:59], v5 offset:26624
    v_mfma_f32_16x16x32_bf16 v[120:123], v[104:107], v[72:75], 0
    ds_read_b64_tr_b16 v[60:61], v6 offset:24576
    v_mfma_f32_16x16x32_bf16 v[124:127], v[104:107], v[76:79], 0
    ds_read_b64_tr_b16 v[62:63], v6 offset:26624
    s_nop 7
    v_add_f32 v28, s67, v120
    v_add_f32 v29, s67, v124
    v_rcp_f32 v28, v28
    v_rcp_f32 v29, v29
    s_nop 0
    v_pk_mul_f32 v[12:13], v[12:13], v[28:29] op_sel:[0,0] op_sel_hi:[1,0]
    v_pk_mul_f32 v[14:15], v[14:15], v[28:29] op_sel:[0,0] op_sel_hi:[1,0]
    v_pk_mul_f32 v[16:17], v[16:17], v[28:29] op_sel:[0,0] op_sel_hi:[1,0]
    v_pk_mul_f32 v[18:19], v[18:19], v[28:29] op_sel:[0,0] op_sel_hi:[1,0]
    v_cvt_pk_bf16_f32 v120, v12, v13
    v_cvt_pk_bf16_f32 v121, v14, v15
    v_cvt_pk_bf16_f32 v122, v16, v17
    v_cvt_pk_bf16_f32 v123, v18, v19
    v_and_b32 v122, v122, v7
    v_and_b32 v123, v123, v7
    v_pk_mul_f32 v[20:21], v[20:21], v[28:29] op_sel:[0,1] op_sel_hi:[1,1]
    v_pk_mul_f32 v[22:23], v[22:23], v[28:29] op_sel:[0,1] op_sel_hi:[1,1]
    v_pk_mul_f32 v[24:25], v[24:25], v[28:29] op_sel:[0,1] op_sel_hi:[1,1]
    v_pk_mul_f32 v[26:27], v[26:27], v[28:29] op_sel:[0,1] op_sel_hi:[1,1]
    v_cvt_pk_bf16_f32 v124, v20, v21
    v_cvt_pk_bf16_f32 v125, v22, v23
    v_cvt_pk_bf16_f32 v126, v24, v25
    v_cvt_pk_bf16_f32 v127, v26, v27
    v_and_b32 v126, v126, v7
    v_and_b32 v127, v127, v7
    s_nop 1
    v_mfma_f32_16x16x32_bf16 v[200:203], v[32:35], v[120:123], 0
    v_mfma_f32_16x16x32_bf16 v[216:219], v[36:39], v[120:123], 0
    v_mfma_f32_16x16x32_bf16 v[232:235], v[40:43], v[120:123], 0
    v_mfma_f32_16x16x32_bf16 v[248:251], v[44:47], v[120:123], 0
    v_mfma_f32_16x16x32_bf16 v[204:207], v[32:35], v[124:127], 0
    v_mfma_f32_16x16x32_bf16 v[220:223], v[36:39], v[124:127], 0
    v_mfma_f32_16x16x32_bf16 v[236:239], v[40:43], v[124:127], 0
    v_mfma_f32_16x16x32_bf16 v[252:255], v[44:47], v[124:127], 0
    s_add_u32 s52, s71, 4096
    buffer_load_dwordx4 v[96:99], v2, s[20:23], s52 offen sc1
    buffer_load_dwordx4 v[100:103], v2, s[20:23], s52 offen offset:1024 sc1
    buffer_load_dwordx4 v[104:107], v8, s[20:23], s52 offen sc1
    s_waitcnt vmcnt(11) lgkmcnt(0)
    v_mfma_f32_16x16x32_bf16 v[12:15], v[108:111], v[80:83], 0
    ds_read_b128 v[64:67], v10 offset:4096
    v_mfma_f32_16x16x32_bf16 v[16:19], v[112:115], v[80:83], 0
    ds_read_b128 v[68:71], v10 offset:5120
    v_mfma_f32_16x16x32_bf16 v[20:23], v[108:111], v[84:87], 0
    ds_read_b128 v[72:75], v10 offset:6144
    v_mfma_f32_16x16x32_bf16 v[24:27], v[112:115], v[84:87], 0
    ds_read_b128 v[76:79], v10 offset:7168
    v_mfma_f32_16x16x32_bf16 v[120:123], v[116:119], v[80:83], 0
    ds_read_b64_tr_b16 v[32:33], v3 offset:0
    v_mfma_f32_16x16x32_bf16 v[124:127], v[116:119], v[84:87], 0
    ds_read_b64_tr_b16 v[34:35], v3 offset:2048
    s_nop 7
    v_add_f32 v28, s67, v120
    v_add_f32 v29, s67, v124
    v_rcp_f32 v28, v28
    v_rcp_f32 v29, v29
    s_nop 0
    v_pk_mul_f32 v[12:13], v[12:13], v[28:29] op_sel:[0,0] op_sel_hi:[1,0]
    v_pk_mul_f32 v[14:15], v[14:15], v[28:29] op_sel:[0,0] op_sel_hi:[1,0]
    v_pk_mul_f32 v[16:17], v[16:17], v[28:29] op_sel:[0,0] op_sel_hi:[1,0]
    v_pk_mul_f32 v[18:19], v[18:19], v[28:29] op_sel:[0,0] op_sel_hi:[1,0]
    v_cvt_pk_bf16_f32 v120, v12, v13
    v_cvt_pk_bf16_f32 v121, v14, v15
    v_cvt_pk_bf16_f32 v122, v16, v17
    v_cvt_pk_bf16_f32 v123, v18, v19
    v_and_b32 v122, v122, v7
    v_and_b32 v123, v123, v7
    v_pk_mul_f32 v[20:21], v[20:21], v[28:29] op_sel:[0,1] op_sel_hi:[1,1]
    v_pk_mul_f32 v[22:23], v[22:23], v[28:29] op_sel:[0,1] op_sel_hi:[1,1]
    v_pk_mul_f32 v[24:25], v[24:25], v[28:29] op_sel:[0,1] op_sel_hi:[1,1]
    v_pk_mul_f32 v[26:27], v[26:27], v[28:29] op_sel:[0,1] op_sel_hi:[1,1]
    v_cvt_pk_bf16_f32 v124, v20, v21
    v_cvt_pk_bf16_f32 v125, v22, v23
    v_cvt_pk_bf16_f32 v126, v24, v25
    v_cvt_pk_bf16_f32 v127, v26, v27
    v_and_b32 v126, v126, v7
    v_and_b32 v127, v127, v7
    s_nop 1
    v_mfma_f32_16x16x32_bf16 v[192:195], v[48:51], v[120:123], v[192:195]
    v_mfma_f32_16x16x32_bf16 v[208:211], v[52:55], v[120:123], v[208:211]
    v_mfma_f32_16x16x32_bf16 v[224:227], v[56:59], v[120:123], v[224:227]
    v_mfma_f32_16x16x32_bf16 v[240:243], v[60:63], v[120:123], v[240:243]
    v_mfma_f32_16x16x32_bf16 v[196:199], v[48:51], v[124:127], v[196:199]
    v_mfma_f32_16x16x32_bf16 v[212:215], v[52:55], v[124:127], v[212:215]
    v_mfma_f32_16x16x32_bf16 v[228:231], v[56:59], v[124:127], v[228:231]
    v_mfma_f32_16x16x32_bf16 v[244:247], v[60:63], v[124:127], v[244:247]
    s_nop 3
    v_mfma_f32_16x16x32_bf16 v[12:15], v[108:111], v[88:91], 0
    ds_read_b64_tr_b16 v[36:37], v4 offset:0
    v_mfma_f32_16x16x32_bf16 v[16:19], v[112:115], v[88:91], 0
    ds_read_b64_tr_b16 v[38:39], v4 offset:2048
    v_mfma_f32_16x16x32_bf16 v[20:23], v[108:111], v[92:95], 0
    ds_read_b64_tr_b16 v[40:41], v5 offset:0
    v_mfma_f32_16x16x32_bf16 v[24:27], v[112:115], v[92:95], 0
    ds_read_b64_tr_b16 v[42:43], v5 offset:2048
    v_mfma_f32_16x16x32_bf16 v[120:123], v[116:119], v[88:91], 0
    ds_read_b64_tr_b16 v[44:45], v6 offset:0
    v_mfma_f32_16x16x32_bf16 v[124:127], v[116:119], v[92:95], 0
    ds_read_b64_tr_b16 v[46:47], v6 offset:2048
    s_nop 7
    v_add_f32 v28, s67, v120
    v_add_f32 v29, s67, v124
    v_rcp_f32 v28, v28
    v_rcp_f32 v29, v29
    s_nop 0
    v_pk_mul_f32 v[12:13], v[12:13], v[28:29] op_sel:[0,0] op_sel_hi:[1,0]
    v_pk_mul_f32 v[14:15], v[14:15], v[28:29] op_sel:[0,0] op_sel_hi:[1,0]
    v_pk_mul_f32 v[16:17], v[16:17], v[28:29] op_sel:[0,0] op_sel_hi:[1,0]
    v_pk_mul_f32 v[18:19], v[18:19], v[28:29] op_sel:[0,0] op_sel_hi:[1,0]
    v_cvt_pk_bf16_f32 v120, v12, v13
    v_cvt_pk_bf16_f32 v121, v14, v15
    v_cvt_pk_bf16_f32 v122, v16, v17
    v_cvt_pk_bf16_f32 v123, v18, v19
    v_and_b32 v122, v122, v7
    v_and_b32 v123, v123, v7
    v_pk_mul_f32 v[20:21], v[20:21], v[28:29] op_sel:[0,1] op_sel_hi:[1,1]
    v_pk_mul_f32 v[22:23], v[22:23], v[28:29] op_sel:[0,1] op_sel_hi:[1,1]
    v_pk_mul_f32 v[24:25], v[24:25], v[28:29] op_sel:[0,1] op_sel_hi:[1,1]
    v_pk_mul_f32 v[26:27], v[26:27], v[28:29] op_sel:[0,1] op_sel_hi:[1,1]
    v_cvt_pk_bf16_f32 v124, v20, v21
    v_cvt_pk_bf16_f32 v125, v22, v23
    v_cvt_pk_bf16_f32 v126, v24, v25
    v_cvt_pk_bf16_f32 v127, v26, v27
    v_and_b32 v126, v126, v7
    v_and_b32 v127, v127, v7
    s_nop 1
    v_mfma_f32_16x16x32_bf16 v[200:203], v[48:51], v[120:123], v[200:203]
    v_mfma_f32_16x16x32_bf16 v[216:219], v[52:55], v[120:123], v[216:219]
    v_mfma_f32_16x16x32_bf16 v[232:235], v[56:59], v[120:123], v[232:235]
    v_mfma_f32_16x16x32_bf16 v[248:251], v[60:63], v[120:123], v[248:251]
    v_mfma_f32_16x16x32_bf16 v[204:207], v[48:51], v[124:127], v[204:207]
    v_mfma_f32_16x16x32_bf16 v[220:223], v[52:55], v[124:127], v[220:223]
    v_mfma_f32_16x16x32_bf16 v[236:239], v[56:59], v[124:127], v[236:239]
    v_mfma_f32_16x16x32_bf16 v[252:255], v[60:63], v[124:127], v[252:255]
    s_add_u32 s52, s71, 6144
    buffer_load_dwordx4 v[108:111], v2, s[20:23], s52 offen sc1
    buffer_load_dwordx4 v[112:115], v2, s[20:23], s52 offen offset:1024 sc1
    buffer_load_dwordx4 v[116:119], v8, s[20:23], s52 offen sc1
    s_waitcnt vmcnt(6) lgkmcnt(0)
    s_waitcnt vmcnt(3)
    v_mfma_f32_16x16x32_bf16 v[12:15], v[96:99], v[64:67], 0
    ds_read_b128 v[80:83], v10 offset:12288
    v_mfma_f32_16x16x32_bf16 v[16:19], v[100:103], v[64:67], 0
    ds_read_b128 v[84:87], v10 offset:13312
    v_mfma_f32_16x16x32_bf16 v[20:23], v[96:99], v[68:71], 0
    ds_read_b128 v[88:91], v10 offset:14336
    v_mfma_f32_16x16x32_bf16 v[24:27], v[100:103], v[68:71], 0
    ds_read_b128 v[92:95], v10 offset:15360
    v_mfma_f32_16x16x32_bf16 v[120:123], v[104:107], v[64:67], 0
    ds_read_b64_tr_b16 v[48:49], v3 offset:8192
    v_mfma_f32_16x16x32_bf16 v[124:127], v[104:107], v[68:71], 0
    ds_read_b64_tr_b16 v[50:51], v3 offset:10240
    s_nop 7
    v_add_f32 v28, s67, v120
    v_add_f32 v29, s67, v124
    v_rcp_f32 v28, v28
    v_rcp_f32 v29, v29
    s_nop 0
    v_pk_mul_f32 v[12:13], v[12:13], v[28:29] op_sel:[0,0] op_sel_hi:[1,0]
    v_pk_mul_f32 v[14:15], v[14:15], v[28:29] op_sel:[0,0] op_sel_hi:[1,0]
    v_pk_mul_f32 v[16:17], v[16:17], v[28:29] op_sel:[0,0] op_sel_hi:[1,0]
    v_pk_mul_f32 v[18:19], v[18:19], v[28:29] op_sel:[0,0] op_sel_hi:[1,0]
    v_cvt_pk_bf16_f32 v120, v12, v13
    v_cvt_pk_bf16_f32 v121, v14, v15
    v_cvt_pk_bf16_f32 v122, v16, v17
    v_cvt_pk_bf16_f32 v123, v18, v19
    v_and_b32 v122, v122, v7
    v_and_b32 v123, v123, v7
    v_pk_mul_f32 v[20:21], v[20:21], v[28:29] op_sel:[0,1] op_sel_hi:[1,1]
    v_pk_mul_f32 v[22:23], v[22:23], v[28:29] op_sel:[0,1] op_sel_hi:[1,1]
    v_pk_mul_f32 v[24:25], v[24:25], v[28:29] op_sel:[0,1] op_sel_hi:[1,1]
    v_pk_mul_f32 v[26:27], v[26:27], v[28:29] op_sel:[0,1] op_sel_hi:[1,1]
    v_cvt_pk_bf16_f32 v124, v20, v21
    v_cvt_pk_bf16_f32 v125, v22, v23
    v_cvt_pk_bf16_f32 v126, v24, v25
    v_cvt_pk_bf16_f32 v127, v26, v27
    v_and_b32 v126, v126, v7
    v_and_b32 v127, v127, v7
    s_nop 1
    v_mfma_f32_16x16x32_bf16 v[192:195], v[32:35], v[120:123], v[192:195]
    v_mfma_f32_16x16x32_bf16 v[208:211], v[36:39], v[120:123], v[208:211]
    v_mfma_f32_16x16x32_bf16 v[224:227], v[40:43], v[120:123], v[224:227]
    v_mfma_f32_16x16x32_bf16 v[240:243], v[44:47], v[120:123], v[240:243]
    v_mfma_f32_16x16x32_bf16 v[196:199], v[32:35], v[124:127], v[196:199]
    v_mfma_f32_16x16x32_bf16 v[212:215], v[36:39], v[124:127], v[212:215]
    v_mfma_f32_16x16x32_bf16 v[228:231], v[40:43], v[124:127], v[228:231]
    v_mfma_f32_16x16x32_bf16 v[244:247], v[44:47], v[124:127], v[244:247]
    s_nop 3
    v_mfma_f32_16x16x32_bf16 v[12:15], v[96:99], v[72:75], 0
    ds_read_b64_tr_b16 v[52:53], v4 offset:8192
    v_mfma_f32_16x16x32_bf16 v[16:19], v[100:103], v[72:75], 0
    ds_read_b64_tr_b16 v[54:55], v4 offset:10240
    v_mfma_f32_16x16x32_bf16 v[20:23], v[96:99], v[76:79], 0
    ds_read_b64_tr_b16 v[56:57], v5 offset:8192
    v_mfma_f32_16x16x32_bf16 v[24:27], v[100:103], v[76:79], 0
    ds_read_b64_tr_b16 v[58:59], v5 offset:10240
    v_mfma_f32_16x16x32_bf16 v[120:123], v[104:107], v[72:75], 0
    ds_read_b64_tr_b16 v[60:61], v6 offset:8192
    v_mfma_f32_16x16x32_bf16 v[124:127], v[104:107], v[76:79], 0
    ds_read_b64_tr_b16 v[62:63], v6 offset:10240
    s_nop 7
    v_add_f32 v28, s67, v120
    v_add_f32 v29, s67, v124
    v_rcp_f32 v28, v28
    v_rcp_f32 v29, v29
    s_nop 0
    v_pk_mul_f32 v[12:13], v[12:13], v[28:29] op_sel:[0,0] op_sel_hi:[1,0]
    v_pk_mul_f32 v[14:15], v[14:15], v[28:29] op_sel:[0,0] op_sel_hi:[1,0]
    v_pk_mul_f32 v[16:17], v[16:17], v[28:29] op_sel:[0,0] op_sel_hi:[1,0]
    v_pk_mul_f32 v[18:19], v[18:19], v[28:29] op_sel:[0,0] op_sel_hi:[1,0]
    v_cvt_pk_bf16_f32 v120, v12, v13
    v_cvt_pk_bf16_f32 v121, v14, v15
    v_cvt_pk_bf16_f32 v122, v16, v17
    v_cvt_pk_bf16_f32 v123, v18, v19
    v_and_b32 v122, v122, v7
    v_and_b32 v123, v123, v7
    v_pk_mul_f32 v[20:21], v[20:21], v[28:29] op_sel:[0,1] op_sel_hi:[1,1]
    v_pk_mul_f32 v[22:23], v[22:23], v[28:29] op_sel:[0,1] op_sel_hi:[1,1]
    v_pk_mul_f32 v[24:25], v[24:25], v[28:29] op_sel:[0,1] op_sel_hi:[1,1]
    v_pk_mul_f32 v[26:27], v[26:27], v[28:29] op_sel:[0,1] op_sel_hi:[1,1]
    v_cvt_pk_bf16_f32 v124, v20, v21
    v_cvt_pk_bf16_f32 v125, v22, v23
    v_cvt_pk_bf16_f32 v126, v24, v25
    v_cvt_pk_bf16_f32 v127, v26, v27
    v_and_b32 v126, v126, v7
    v_and_b32 v127, v127, v7
    s_nop 1
    v_mfma_f32_16x16x32_bf16 v[200:203], v[32:35], v[120:123], v[200:203]
    v_mfma_f32_16x16x32_bf16 v[216:219], v[36:39], v[120:123], v[216:219]
    v_mfma_f32_16x16x32_bf16 v[232:235], v[40:43], v[120:123], v[232:235]
    v_mfma_f32_16x16x32_bf16 v[248:251], v[44:47], v[120:123], v[248:251]
    v_mfma_f32_16x16x32_bf16 v[204:207], v[32:35], v[124:127], v[204:207]
    v_mfma_f32_16x16x32_bf16 v[220:223], v[36:39], v[124:127], v[220:223]
    v_mfma_f32_16x16x32_bf16 v[236:239], v[40:43], v[124:127], v[236:239]
    v_mfma_f32_16x16x32_bf16 v[252:255], v[44:47], v[124:127], v[252:255]
    s_waitcnt lgkmcnt(0)
    s_waitcnt vmcnt(0)
    v_mfma_f32_16x16x32_bf16 v[12:15], v[108:111], v[80:83], 0
    v_mfma_f32_16x16x32_bf16 v[16:19], v[112:115], v[80:83], 0
    v_mfma_f32_16x16x32_bf16 v[20:23], v[108:111], v[84:87], 0
    v_mfma_f32_16x16x32_bf16 v[24:27], v[112:115], v[84:87], 0
    v_mfma_f32_16x16x32_bf16 v[120:123], v[116:119], v[80:83], 0
    v_mfma_f32_16x16x32_bf16 v[124:127], v[116:119], v[84:87], 0
    s_nop 7
    v_add_f32 v28, s67, v120
    v_add_f32 v29, s67, v124
    v_rcp_f32 v28, v28
    v_rcp_f32 v29, v29
    s_nop 0
    v_pk_mul_f32 v[12:13], v[12:13], v[28:29] op_sel:[0,0] op_sel_hi:[1,0]
    v_pk_mul_f32 v[14:15], v[14:15], v[28:29] op_sel:[0,0] op_sel_hi:[1,0]
    v_pk_mul_f32 v[16:17], v[16:17], v[28:29] op_sel:[0,0] op_sel_hi:[1,0]
    v_pk_mul_f32 v[18:19], v[18:19], v[28:29] op_sel:[0,0] op_sel_hi:[1,0]
    v_cvt_pk_bf16_f32 v120, v12, v13
    v_cvt_pk_bf16_f32 v121, v14, v15
    v_cvt_pk_bf16_f32 v122, v16, v17
    v_cvt_pk_bf16_f32 v123, v18, v19
    v_and_b32 v122, v122, v7
    v_and_b32 v123, v123, v7
    v_pk_mul_f32 v[20:21], v[20:21], v[28:29] op_sel:[0,1] op_sel_hi:[1,1]
    v_pk_mul_f32 v[22:23], v[22:23], v[28:29] op_sel:[0,1] op_sel_hi:[1,1]
    v_pk_mul_f32 v[24:25], v[24:25], v[28:29] op_sel:[0,1] op_sel_hi:[1,1]
    v_pk_mul_f32 v[26:27], v[26:27], v[28:29] op_sel:[0,1] op_sel_hi:[1,1]
    v_cvt_pk_bf16_f32 v124, v20, v21
    v_cvt_pk_bf16_f32 v125, v22, v23
    v_cvt_pk_bf16_f32 v126, v24, v25
    v_cvt_pk_bf16_f32 v127, v26, v27
    v_and_b32 v126, v126, v7
    v_and_b32 v127, v127, v7
    s_nop 1
    v_mfma_f32_16x16x32_bf16 v[192:195], v[48:51], v[120:123], v[192:195]
    v_mfma_f32_16x16x32_bf16 v[208:211], v[52:55], v[120:123], v[208:211]
    v_mfma_f32_16x16x32_bf16 v[224:227], v[56:59], v[120:123], v[224:227]
    v_mfma_f32_16x16x32_bf16 v[240:243], v[60:63], v[120:123], v[240:243]
    v_mfma_f32_16x16x32_bf16 v[196:199], v[48:51], v[124:127], v[196:199]
    v_mfma_f32_16x16x32_bf16 v[212:215], v[52:55], v[124:127], v[212:215]
    v_mfma_f32_16x16x32_bf16 v[228:231], v[56:59], v[124:127], v[228:231]
    v_mfma_f32_16x16x32_bf16 v[244:247], v[60:63], v[124:127], v[244:247]
    s_nop 3
    v_mfma_f32_16x16x32_bf16 v[12:15], v[108:111], v[88:91], 0
    v_mfma_f32_16x16x32_bf16 v[16:19], v[112:115], v[88:91], 0
    v_mfma_f32_16x16x32_bf16 v[20:23], v[108:111], v[92:95], 0
    v_mfma_f32_16x16x32_bf16 v[24:27], v[112:115], v[92:95], 0
    v_mfma_f32_16x16x32_bf16 v[120:123], v[116:119], v[88:91], 0
    v_mfma_f32_16x16x32_bf16 v[124:127], v[116:119], v[92:95], 0
    s_nop 7
    v_add_f32 v28, s67, v120
    v_add_f32 v29, s67, v124
    v_rcp_f32 v28, v28
    v_rcp_f32 v29, v29
    s_nop 0
    v_pk_mul_f32 v[12:13], v[12:13], v[28:29] op_sel:[0,0] op_sel_hi:[1,0]
    v_pk_mul_f32 v[14:15], v[14:15], v[28:29] op_sel:[0,0] op_sel_hi:[1,0]
    v_pk_mul_f32 v[16:17], v[16:17], v[28:29] op_sel:[0,0] op_sel_hi:[1,0]
    v_pk_mul_f32 v[18:19], v[18:19], v[28:29] op_sel:[0,0] op_sel_hi:[1,0]
    v_cvt_pk_bf16_f32 v120, v12, v13
    v_cvt_pk_bf16_f32 v121, v14, v15
    v_cvt_pk_bf16_f32 v122, v16, v17
    v_cvt_pk_bf16_f32 v123, v18, v19
    v_and_b32 v122, v122, v7
    v_and_b32 v123, v123, v7
    v_pk_mul_f32 v[20:21], v[20:21], v[28:29] op_sel:[0,1] op_sel_hi:[1,1]
    v_pk_mul_f32 v[22:23], v[22:23], v[28:29] op_sel:[0,1] op_sel_hi:[1,1]
    v_pk_mul_f32 v[24:25], v[24:25], v[28:29] op_sel:[0,1] op_sel_hi:[1,1]
    v_pk_mul_f32 v[26:27], v[26:27], v[28:29] op_sel:[0,1] op_sel_hi:[1,1]
    v_cvt_pk_bf16_f32 v124, v20, v21
    v_cvt_pk_bf16_f32 v125, v22, v23
    v_cvt_pk_bf16_f32 v126, v24, v25
    v_cvt_pk_bf16_f32 v127, v26, v27
    v_and_b32 v126, v126, v7
    v_and_b32 v127, v127, v7
    s_nop 1
    v_mfma_f32_16x16x32_bf16 v[200:203], v[48:51], v[120:123], v[200:203]
    v_mfma_f32_16x16x32_bf16 v[216:219], v[52:55], v[120:123], v[216:219]
    v_mfma_f32_16x16x32_bf16 v[232:235], v[56:59], v[120:123], v[232:235]
    v_mfma_f32_16x16x32_bf16 v[248:251], v[60:63], v[120:123], v[248:251]
    v_mfma_f32_16x16x32_bf16 v[204:207], v[48:51], v[124:127], v[204:207]
    v_mfma_f32_16x16x32_bf16 v[220:223], v[52:55], v[124:127], v[220:223]
    v_mfma_f32_16x16x32_bf16 v[236:239], v[56:59], v[124:127], v[236:239]
    v_mfma_f32_16x16x32_bf16 v[252:255], v[60:63], v[124:127], v[252:255]
    s_nop 9
    s_barrier
    s_lshl_b32 s52, s50, 13
    v_add_u32 v11, s52, v2
    s_cmp_eq_u32 s50, 0
    s_cbranch_scc1 K2_SKIPW0
    v_add_u32 v12, 0, v11
    ds_write_b128 v12, v[128:131] offset:0
    ds_write_b128 v12, v[144:147] offset:1024
    ds_write_b128 v12, v[160:163] offset:2048
    ds_write_b128 v12, v[176:179] offset:3072
    ds_write_b128 v12, v[192:195] offset:4096
    ds_write_b128 v12, v[208:211] offset:5120
    ds_write_b128 v12, v[224:227] offset:6144
    ds_write_b128 v12, v[240:243] offset:7168
K2_SKIPW0:
    s_cmp_eq_u32 s50, 1
    s_cbranch_scc1 K2_SKIPW1
    v_add_u32 v12, 32768, v11
    ds_write_b128 v12, v[132:135] offset:0
    ds_write_b128 v12, v[148:151] offset:1024
    ds_write_b128 v12, v[164:167] offset:2048
    ds_write_b128 v12, v[180:183] offset:3072
    ds_write_b128 v12, v[196:199] offset:4096
    ds_write_b128 v12, v[212:215] offset:5120
    ds_write_b128 v12, v[228:231] offset:6144
    ds_write_b128 v12, v[244:247] offset:7168
K2_SKIPW1:
    s_cmp_eq_u32 s50, 2
    s_cbranch_scc1 K2_SKIPW2
    v_add_u32 v12, 65536, v11
    ds_write_b128 v12, v[136:139] offset:0
    ds_write_b128 v12, v[152:155] offset:1024
    ds_write_b128 v12, v[168:171] offset:2048
    ds_write_b128 v12, v[184:187] offset:3072
    ds_write_b128 v12, v[200:203] offset:4096
    ds_write_b128 v12, v[216:219] offset:5120
    ds_write_b128 v12, v[232:235] offset:6144
    ds_write_b128 v12, v[248:251] offset:7168
K2_SKIPW2:
    s_cmp_eq_u32 s50, 3
    s_cbranch_scc1 K2_SKIPW3
    v_add_u32 v12, 98304, v11
    ds_write_b128 v12, v[140:143] offset:0
    ds_write_b128 v12, v[156:159] offset:1024
    ds_write_b128 v12, v[172:175] offset:2048
    ds_write_b128 v12, v[188:191] offset:3072
    ds_write_b128 v12, v[204:207] offset:4096
    ds_write_b128 v12, v[220:223] offset:5120
    ds_write_b128 v12, v[236:239] offset:6144
    ds_write_b128 v12, v[252:255] offset:7168
K2_SKIPW3:
    s_cmp_lg_u32 s50, 0
    s_cbranch_scc1 K2_SKIPM0
    v_pk_mov_b32 v[32:33], v[128:129], v[128:129] op_sel:[0,1]
    v_pk_mov_b32 v[34:35], v[130:131], v[130:131] op_sel:[0,1]
    v_pk_mov_b32 v[36:37], v[144:145], v[144:145] op_sel:[0,1]
    v_pk_mov_b32 v[38:39], v[146:147], v[146:147] op_sel:[0,1]
    v_pk_mov_b32 v[40:41], v[160:161], v[160:161] op_sel:[0,1]
    v_pk_mov_b32 v[42:43], v[162:163], v[162:163] op_sel:[0,1]
    v_pk_mov_b32 v[44:45], v[176:177], v[176:177] op_sel:[0,1]
    v_pk_mov_b32 v[46:47], v[178:179], v[178:179] op_sel:[0,1]
    v_pk_mov_b32 v[48:49], v[192:193], v[192:193] op_sel:[0,1]
    v_pk_mov_b32 v[50:51], v[194:195], v[194:195] op_sel:[0,1]
    v_pk_mov_b32 v[52:53], v[208:209], v[208:209] op_sel:[0,1]
    v_pk_mov_b32 v[54:55], v[210:211], v[210:211] op_sel:[0,1]
    v_pk_mov_b32 v[56:57], v[224:225], v[224:225] op_sel:[0,1]
    v_pk_mov_b32 v[58:59], v[226:227], v[226:227] op_sel:[0,1]
    v_pk_mov_b32 v[60:61], v[240:241], v[240:241] op_sel:[0,1]
    v_pk_mov_b32 v[62:63], v[242:243], v[242:243] op_sel:[0,1]
K2_SKIPM0:
    s_cmp_lg_u32 s50, 1
    s_cbranch_scc1 K2_SKIPM1
    v_pk_mov_b32 v[32:33], v[132:133], v[132:133] op_sel:[0,1]
    v_pk_mov_b32 v[34:35], v[134:135], v[134:135] op_sel:[0,1]
    v_pk_mov_b32 v[36:37], v[148:149], v[148:149] op_sel:[0,1]
    v_pk_mov_b32 v[38:39], v[150:151], v[150:151] op_sel:[0,1]
    v_pk_mov_b32 v[40:41], v[164:165], v[164:165] op_sel:[0,1]
    v_pk_mov_b32 v[42:43], v[166:167], v[166:167] op_sel:[0,1]
    v_pk_mov_b32 v[44:45], v[180:181], v[180:181] op_sel:[0,1]
    v_pk_mov_b32 v[46:47], v[182:183], v[182:183] op_sel:[0,1]
    v_pk_mov_b32 v[48:49], v[196:197], v[196:197] op_sel:[0,1]
    v_pk_mov_b32 v[50:51], v[198:199], v[198:199] op_sel:[0,1]
    v_pk_mov_b32 v[52:53], v[212:213], v[212:213] op_sel:[0,1]
    v_pk_mov_b32 v[54:55], v[214:215], v[214:215] op_sel:[0,1]
    v_pk_mov_b32 v[56:57], v[228:229], v[228:229] op_sel:[0,1]
    v_pk_mov_b32 v[58:59], v[230:231], v[230:231] op_sel:[0,1]
    v_pk_mov_b32 v[60:61], v[244:245], v[244:245] op_sel:[0,1]
    v_pk_mov_b32 v[62:63], v[246:247], v[246:247] op_sel:[0,1]
K2_SKIPM1:
    s_cmp_lg_u32 s50, 2
    s_cbranch_scc1 K2_SKIPM2
    v_pk_mov_b32 v[32:33], v[136:137], v[136:137] op_sel:[0,1]
    v_pk_mov_b32 v[34:35], v[138:139], v[138:139] op_sel:[0,1]
    v_pk_mov_b32 v[36:37], v[152:153], v[152:153] op_sel:[0,1]
    v_pk_mov_b32 v[38:39], v[154:155], v[154:155] op_sel:[0,1]
    v_pk_mov_b32 v[40:41], v[168:169], v[168:169] op_sel:[0,1]
    v_pk_mov_b32 v[42:43], v[170:171], v[170:171] op_sel:[0,1]
    v_pk_mov_b32 v[44:45], v[184:185], v[184:185] op_sel:[0,1]
    v_pk_mov_b32 v[46:47], v[186:187], v[186:187] op_sel:[0,1]
    v_pk_mov_b32 v[48:49], v[200:201], v[200:201] op_sel:[0,1]
    v_pk_mov_b32 v[50:51], v[202:203], v[202:203] op_sel:[0,1]
    v_pk_mov_b32 v[52:53], v[216:217], v[216:217] op_sel:[0,1]
    v_pk_mov_b32 v[54:55], v[218:219], v[218:219] op_sel:[0,1]
    v_pk_mov_b32 v[56:57], v[232:233], v[232:233] op_sel:[0,1]
    v_pk_mov_b32 v[58:59], v[234:235], v[234:235] op_sel:[0,1]
    v_pk_mov_b32 v[60:61], v[248:249], v[248:249] op_sel:[0,1]
    v_pk_mov_b32 v[62:63], v[250:251], v[250:251] op_sel:[0,1]
K2_SKIPM2:
    s_cmp_lg_u32 s50, 3
    s_cbranch_scc1 K2_SKIPM3
    v_pk_mov_b32 v[32:33], v[140:141], v[140:141] op_sel:[0,1]
    v_pk_mov_b32 v[34:35], v[142:143], v[142:143] op_sel:[0,1]
    v_pk_mov_b32 v[36:37], v[156:157], v[156:157] op_sel:[0,1]
    v_pk_mov_b32 v[38:39], v[158:159], v[158:159] op_sel:[0,1]
    v_pk_mov_b32 v[40:41], v[172:173], v[172:173] op_sel:[0,1]
    v_pk_mov_b32 v[42:43], v[174:175], v[174:175] op_sel:[0,1]
    v_pk_mov_b32 v[44:45], v[188:189], v[188:189] op_sel:[0,1]
    v_pk_mov_b32 v[46:47], v[190:191], v[190:191] op_sel:[0,1]
    v_pk_mov_b32 v[48:49], v[204:205], v[204:205] op_sel:[0,1]
    v_pk_mov_b32 v[50:51], v[206:207], v[206:207] op_sel:[0,1]
    v_pk_mov_b32 v[52:53], v[220:221], v[220:221] op_sel:[0,1]
    v_pk_mov_b32 v[54:55], v[222:223], v[222:223] op_sel:[0,1]
    v_pk_mov_b32 v[56:57], v[236:237], v[236:237] op_sel:[0,1]
    v_pk_mov_b32 v[58:59], v[238:239], v[238:239] op_sel:[0,1]
    v_pk_mov_b32 v[60:61], v[252:253], v[252:253] op_sel:[0,1]
    v_pk_mov_b32 v[62:63], v[254:255], v[254:255] op_sel:[0,1]
K2_SKIPM3:
    s_waitcnt lgkmcnt(0)
    s_barrier
    s_lshl_b32 s52, s50, 15
    v_add_u32 v11, s52, v2
    s_add_u32 s53, s50, 1
    s_and_b32 s53, s53, 3
    s_lshl_b32 s53, s53, 13
    v_add_u32 v12, s53, v11
    ds_read_b128 v[64:67], v12 offset:0
    ds_read_b128 v[68:71], v12 offset:1024
    ds_read_b128 v[72:75], v12 offset:2048
    ds_read_b128 v[76:79], v12 offset:3072
    ds_read_b128 v[80:83], v12 offset:4096
    ds_read_b128 v[84:87], v12 offset:5120
    ds_read_b128 v[88:91], v12 offset:6144
    ds_read_b128 v[92:95], v12 offset:7168
    s_add_u32 s53, s50, 2
    s_and_b32 s53, s53, 3
    s_lshl_b32 s53, s53, 13
    v_add_u32 v13, s53, v11
    ds_read_b128 v[96:99], v13 offset:0
    ds_read_b128 v[100:103], v13 offset:1024
    ds_read_b128 v[104:107], v13 offset:2048
    ds_read_b128 v[108:111], v13 offset:3072
    ds_read_b128 v[112:115], v13 offset:4096
    ds_read_b128 v[116:119], v13 offset:5120
    ds_read_b128 v[120:123], v13 offset:6144
    ds_read_b128 v[124:127], v13 offset:7168
    s_add_u32 s53, s50, 3
    s_and_b32 s53, s53, 3
    s_lshl_b32 s53, s53, 13
    v_add_u32 v14, s53, v11
    ds_read_b128 v[128:131], v14 offset:0
    ds_read_b128 v[132:135], v14 offset:1024
    ds_read_b128 v[136:139], v14 offset:2048
    ds_read_b128 v[140:143], v14 offset:3072
    ds_read_b128 v[144:147], v14 offset:4096
    ds_read_b128 v[148:151], v14 offset:5120
    ds_read_b128 v[152:155], v14 offset:6144
    ds_read_b128 v[156:159], v14 offset:7168
    s_waitcnt lgkmcnt(15)
    v_pk_add_f32 v[32:33], v[32:33], v[64:65]
    v_pk_add_f32 v[34:35], v[34:35], v[66:67]
    v_pk_add_f32 v[36:37], v[36:37], v[68:69]
    v_pk_add_f32 v[38:39], v[38:39], v[70:71]
    v_pk_add_f32 v[40:41], v[40:41], v[72:73]
    v_pk_add_f32 v[42:43], v[42:43], v[74:75]
    v_pk_add_f32 v[44:45], v[44:45], v[76:77]
    v_pk_add_f32 v[46:47], v[46:47], v[78:79]
    v_pk_add_f32 v[48:49], v[48:49], v[80:81]
    v_pk_add_f32 v[50:51], v[50:51], v[82:83]
    v_pk_add_f32 v[52:53], v[52:53], v[84:85]
    v_pk_add_f32 v[54:55], v[54:55], v[86:87]
    v_pk_add_f32 v[56:57], v[56:57], v[88:89]
    v_pk_add_f32 v[58:59], v[58:59], v[90:91]
    v_pk_add_f32 v[60:61], v[60:61], v[92:93]
    v_pk_add_f32 v[62:63], v[62:63], v[94:95]
    s_waitcnt lgkmcnt(8)
    v_pk_add_f32 v[32:33], v[32:33], v[96:97]
    v_pk_add_f32 v[34:35], v[34:35], v[98:99]
    v_pk_add_f32 v[36:37], v[36:37], v[100:101]
    v_pk_add_f32 v[38:39], v[38:39], v[102:103]
    v_pk_add_f32 v[40:41], v[40:41], v[104:105]
    v_pk_add_f32 v[42:43], v[42:43], v[106:107]
    v_pk_add_f32 v[44:45], v[44:45], v[108:109]
    v_pk_add_f32 v[46:47], v[46:47], v[110:111]
    v_pk_add_f32 v[48:49], v[48:49], v[112:113]
    v_pk_add_f32 v[50:51], v[50:51], v[114:115]
    v_pk_add_f32 v[52:53], v[52:53], v[116:117]
    v_pk_add_f32 v[54:55], v[54:55], v[118:119]
    v_pk_add_f32 v[56:57], v[56:57], v[120:121]
    v_pk_add_f32 v[58:59], v[58:59], v[122:123]
    v_pk_add_f32 v[60:61], v[60:61], v[124:125]
    v_pk_add_f32 v[62:63], v[62:63], v[126:127]
    s_waitcnt lgkmcnt(0)
    v_pk_add_f32 v[32:33], v[32:33], v[128:129]
    v_pk_add_f32 v[34:35], v[34:35], v[130:131]
    v_pk_add_f32 v[36:37], v[36:37], v[132:133]
    v_pk_add_f32 v[38:39], v[38:39], v[134:135]
    v_pk_add_f32 v[40:41], v[40:41], v[136:137]
    v_pk_add_f32 v[42:43], v[42:43], v[138:139]
    v_pk_add_f32 v[44:45], v[44:45], v[140:141]
    v_pk_add_f32 v[46:47], v[46:47], v[142:143]
    v_pk_add_f32 v[48:49], v[48:49], v[144:145]
    v_pk_add_f32 v[50:51], v[50:51], v[146:147]
    v_pk_add_f32 v[52:53], v[52:53], v[148:149]
    v_pk_add_f32 v[54:55], v[54:55], v[150:151]
    v_pk_add_f32 v[56:57], v[56:57], v[152:153]
    v_pk_add_f32 v[58:59], v[58:59], v[154:155]
    v_pk_add_f32 v[60:61], v[60:61], v[156:157]
    v_pk_add_f32 v[62:63], v[62:63], v[158:159]
    v_sub_f32 v14, 1.0, v9
    v_cvt_pk_bf16_f32 v14, v14, v14
    v_lshlrev_b32 v14, 16, v14
    v_mov_b32 v15, v14
    v_mov_b32 v16, v9
    v_mov_b32 v17, v9
    v_and_b32 v18, 15, v1
    v_mul_u32_u24 v18, 896, v18
    v_lshrrev_b32 v19, 4, v1
    v_lshl_add_u32 v18, v19, 3, v18
    s_lshl_b32 s52, s44, 6
    s_lshl_b32 s53, s50, 4
    s_add_u32 s52, s52, s53
    s_mul_i32 s52, s52, 896
    s_lshl_b32 s53, s45, 7
    s_add_u32 s52, s52, s53
    v_pk_mul_f32 v[32:33], v[32:33], v[14:15]
    v_pk_fma_f32 v[32:33], v[48:49], v[16:17], v[32:33]
    v_cvt_pk_bf16_f32 v72, v32, v33
    v_pk_mul_f32 v[34:35], v[34:35], v[14:15]
    v_pk_fma_f32 v[34:35], v[50:51], v[16:17], v[34:35]
    v_cvt_pk_bf16_f32 v73, v34, v35
    buffer_store_dwordx2 v[72:73], v18, s[36:39], s52 offen offset:0
    v_pk_mul_f32 v[36:37], v[36:37], v[14:15]
    v_pk_fma_f32 v[36:37], v[52:53], v[16:17], v[36:37]
    v_cvt_pk_bf16_f32 v74, v36, v37
    v_pk_mul_f32 v[38:39], v[38:39], v[14:15]
    v_pk_fma_f32 v[38:39], v[54:55], v[16:17], v[38:39]
    v_cvt_pk_bf16_f32 v75, v38, v39
    buffer_store_dwordx2 v[74:75], v18, s[36:39], s52 offen offset:32
    v_pk_mul_f32 v[40:41], v[40:41], v[14:15]
    v_pk_fma_f32 v[40:41], v[56:57], v[16:17], v[40:41]
    v_cvt_pk_bf16_f32 v76, v40, v41
    v_pk_mul_f32 v[42:43], v[42:43], v[14:15]
    v_pk_fma_f32 v[42:43], v[58:59], v[16:17], v[42:43]
    v_cvt_pk_bf16_f32 v77, v42, v43
    buffer_store_dwordx2 v[76:77], v18, s[36:39], s52 offen offset:64
    v_pk_mul_f32 v[44:45], v[44:45], v[14:15]
    v_pk_fma_f32 v[44:45], v[60:61], v[16:17], v[44:45]
    v_cvt_pk_bf16_f32 v78, v44, v45
    v_pk_mul_f32 v[46:47], v[46:47], v[14:15]
    v_pk_fma_f32 v[46:47], v[62:63], v[16:17], v[46:47]
    v_cvt_pk_bf16_f32 v79, v46, v47
    buffer_store_dwordx2 v[78:79], v18, s[36:39], s52 offen offset:96
    s_branch K2_END
K2_RED:
    s_and_b32 s52, s2, 7
    s_lshl_b32 s55, s52, 1
    s_add_u32 s55, s55, s75
    s_lshl_b32 s52, s55, 17
    s_lshl_b32 s53, s50, 10
    s_add_u32 s52, s52, s53
    s_add_u32 s52, s52, 9437184
    s_add_u32 s53, s52, 0
    buffer_load_dwordx4 v[32:35], v2, s[20:23], s53 offen
    s_add_u32 s53, s52, 4096
    buffer_load_dwordx4 v[36:39], v2, s[20:23], s53 offen
    s_add_u32 s53, s52, 8192
    buffer_load_dwordx4 v[40:43], v2, s[20:23], s53 offen
    s_add_u32 s53, s52, 12288
    buffer_load_dwordx4 v[44:47], v2, s[20:23], s53 offen
    s_add_u32 s53, s52, 16384
    buffer_load_dwordx4 v[48:51], v2, s[20:23], s53 offen
    s_add_u32 s53, s52, 20480
    buffer_load_dwordx4 v[52:55], v2, s[20:23], s53 offen
    s_add_u32 s53, s52, 24576
    buffer_load_dwordx4 v[56:59], v2, s[20:23], s53 offen
    s_add_u32 s53, s52, 28672
    buffer_load_dwordx4 v[60:63], v2, s[20:23], s53 offen
    s_add_u32 s53, s52, 32768
    buffer_load_dwordx4 v[64:67], v2, s[20:23], s53 offen
    s_add_u32 s53, s52, 36864
    buffer_load_dwordx4 v[68:71], v2, s[20:23], s53 offen
    s_add_u32 s53, s52, 40960
    buffer_load_dwordx4 v[72:75], v2, s[20:23], s53 offen
    s_add_u32 s53, s52, 45056
    buffer_load_dwordx4 v[76:79], v2, s[20:23], s53 offen
    s_add_u32 s53, s52, 49152
    buffer_load_dwordx4 v[80:83], v2, s[20:23], s53 offen
    s_add_u32 s53, s52, 53248
    buffer_load_dwordx4 v[84:87], v2, s[20:23], s53 offen
    s_add_u32 s53, s52, 57344
    buffer_load_dwordx4 v[88:91], v2, s[20:23], s53 offen
    s_add_u32 s53, s52, 61440
    buffer_load_dwordx4 v[92:95], v2, s[20:23], s53 offen
    s_add_u32 s53, s52, 65536
    buffer_load_dwordx4 v[96:99], v2, s[20:23], s53 offen
    s_add_u32 s53, s52, 69632
    buffer_load_dwordx4 v[100:103], v2, s[20:23], s53 offen
    s_add_u32 s53, s52, 73728
    buffer_load_dwordx4 v[104:107], v2, s[20:23], s53 offen
    s_add_u32 s53, s52, 77824
    buffer_load_dwordx4 v[108:111], v2, s[20:23], s53 offen
    s_add_u32 s53, s52, 81920
    buffer_load_dwordx4 v[112:115], v2, s[20:23], s53 offen
    s_add_u32 s53, s52, 86016
    buffer_load_dwordx4 v[116:119], v2, s[20:23], s53 offen
    s_add_u32 s53, s52, 90112
    buffer_load_dwordx4 v[120:123], v2, s[20:23], s53 offen
    s_add_u32 s53, s52, 94208
    buffer_load_dwordx4 v[124:127], v2, s[20:23], s53 offen
    s_add_u32 s53, s52, 98304
    buffer_load_dwordx4 v[128:131], v2, s[20:23], s53 offen
    s_add_u32 s53, s52, 102400
    buffer_load_dwordx4 v[132:135], v2, s[20:23], s53 offen
    s_add_u32 s53, s52, 106496
    buffer_load_dwordx4 v[136:139], v2, s[20:23], s53 offen
    s_add_u32 s53, s52, 110592
    buffer_load_dwordx4 v[140:143], v2, s[20:23], s53 offen
    s_add_u32 s53, s52, 114688
    buffer_load_dwordx4 v[144:147], v2, s[20:23], s53 offen
    s_add_u32 s53, s52, 118784
    buffer_load_dwordx4 v[148:151], v2, s[20:23], s53 offen
    s_add_u32 s53, s52, 122880
    buffer_load_dwordx4 v[152:155], v2, s[20:23], s53 offen
    s_add_u32 s53, s52, 126976
    buffer_load_dwordx4 v[156:159], v2, s[20:23], s53 offen
    s_waitcnt vmcnt(30)
    v_pk_add_f32 v[32:33], v[32:33], v[36:37]
    v_pk_add_f32 v[34:35], v[34:35], v[38:39]
    s_waitcnt vmcnt(29)
    v_pk_add_f32 v[32:33], v[32:33], v[40:41]
    v_pk_add_f32 v[34:35], v[34:35], v[42:43]
    s_waitcnt vmcnt(28)
    v_pk_add_f32 v[32:33], v[32:33], v[44:45]
    v_pk_add_f32 v[34:35], v[34:35], v[46:47]
    s_waitcnt vmcnt(27)
    v_pk_add_f32 v[32:33], v[32:33], v[48:49]
    v_pk_add_f32 v[34:35], v[34:35], v[50:51]
    s_waitcnt vmcnt(26)
    v_pk_add_f32 v[32:33], v[32:33], v[52:53]
    v_pk_add_f32 v[34:35], v[34:35], v[54:55]
    s_waitcnt vmcnt(25)
    v_pk_add_f32 v[32:33], v[32:33], v[56:57]
    v_pk_add_f32 v[34:35], v[34:35], v[58:59]
    s_waitcnt vmcnt(24)
    v_pk_add_f32 v[32:33], v[32:33], v[60:61]
    v_pk_add_f32 v[34:35], v[34:35], v[62:63]
    s_waitcnt vmcnt(23)
    v_pk_add_f32 v[32:33], v[32:33], v[64:65]
    v_pk_add_f32 v[34:35], v[34:35], v[66:67]
    s_waitcnt vmcnt(22)
    v_pk_add_f32 v[32:33], v[32:33], v[68:69]
    v_pk_add_f32 v[34:35], v[34:35], v[70:71]
    s_waitcnt vmcnt(21)
    v_pk_add_f32 v[32:33], v[32:33], v[72:73]
    v_pk_add_f32 v[34:35], v[34:35], v[74:75]
    s_waitcnt vmcnt(20)
    v_pk_add_f32 v[32:33], v[32:33], v[76:77]
    v_pk_add_f32 v[34:35], v[34:35], v[78:79]
    s_waitcnt vmcnt(19)
    v_pk_add_f32 v[32:33], v[32:33], v[80:81]
    v_pk_add_f32 v[34:35], v[34:35], v[82:83]
    s_waitcnt vmcnt(18)
    v_pk_add_f32 v[32:33], v[32:33], v[84:85]
    v_pk_add_f32 v[34:35], v[34:35], v[86:87]
    s_waitcnt vmcnt(17)
    v_pk_add_f32 v[32:33], v[32:33], v[88:89]
    v_pk_add_f32 v[34:35], v[34:35], v[90:91]
    s_waitcnt vmcnt(16)
    v_pk_add_f32 v[32:33], v[32:33], v[92:93]
    v_pk_add_f32 v[34:35], v[34:35], v[94:95]
    s_waitcnt vmcnt(15)
    v_pk_add_f32 v[32:33], v[32:33], v[96:97]
    v_pk_add_f32 v[34:35], v[34:35], v[98:99]
    s_waitcnt vmcnt(14)
    v_pk_add_f32 v[32:33], v[32:33], v[100:101]
    v_pk_add_f32 v[34:35], v[34:35], v[102:103]
    s_waitcnt vmcnt(13)
    v_pk_add_f32 v[32:33], v[32:33], v[104:105]
    v_pk_add_f32 v[34:35], v[34:35], v[106:107]
    s_waitcnt vmcnt(12)
    v_pk_add_f32 v[32:33], v[32:33], v[108:109]
    v_pk_add_f32 v[34:35], v[34:35], v[110:111]
    s_waitcnt vmcnt(11)
    v_pk_add_f32 v[32:33], v[32:33], v[112:113]
    v_pk_add_f32 v[34:35], v[34:35], v[114:115]
    s_waitcnt vmcnt(10)
    v_pk_add_f32 v[32:33], v[32:33], v[116:117]
    v_pk_add_f32 v[34:35], v[34:35], v[118:119]
    s_waitcnt vmcnt(9)
    v_pk_add_f32 v[32:33], v[32:33], v[120:121]
    v_pk_add_f32 v[34:35], v[34:35], v[122:123]
    s_waitcnt vmcnt(8)
    v_pk_add_f32 v[32:33], v[32:33], v[124:125]
    v_pk_add_f32 v[34:35], v[34:35], v[126:127]
    s_waitcnt vmcnt(7)
    v_pk_add_f32 v[32:33], v[32:33], v[128:129]
    v_pk_add_f32 v[34:35], v[34:35], v[130:131]
    s_waitcnt vmcnt(6)
    v_pk_add_f32 v[32:33], v[32:33], v[132:133]
    v_pk_add_f32 v[34:35], v[34:35], v[134:135]
    s_waitcnt vmcnt(5)
    v_pk_add_f32 v[32:33], v[32:33], v[136:137]
    v_pk_add_f32 v[34:35], v[34:35], v[138:139]
    s_waitcnt vmcnt(4)
    v_pk_add_f32 v[32:33], v[32:33], v[140:141]
    v_pk_add_f32 v[34:35], v[34:35], v[142:143]
    s_waitcnt vmcnt(3)
    v_pk_add_f32 v[32:33], v[32:33], v[144:145]
    v_pk_add_f32 v[34:35], v[34:35], v[146:147]
    s_waitcnt vmcnt(2)
    v_pk_add_f32 v[32:33], v[32:33], v[148:149]
    v_pk_add_f32 v[34:35], v[34:35], v[150:151]
    s_waitcnt vmcnt(1)
    v_pk_add_f32 v[32:33], v[32:33], v[152:153]
    v_pk_add_f32 v[34:35], v[34:35], v[154:155]
    s_waitcnt vmcnt(0)
    v_pk_add_f32 v[32:33], v[32:33], v[156:157]
    v_pk_add_f32 v[34:35], v[34:35], v[158:159]
    v_cvt_pk_bf16_f32 v20, v32, v33
    v_cvt_pk_bf16_f32 v21, v34, v35
    s_lshl_b32 s52, s55, 11
    s_and_b32 s53, s50, 1
    s_lshl_b32 s53, s53, 10
    s_add_u32 s52, s52, s53
    s_lshr_b32 s53, s50, 1
    s_lshl_b32 s53, s53, 3
    s_add_u32 s52, s52, s53
    s_add_u32 s52, s52, 11534336
    buffer_store_dwordx2 v[20:21], v2, s[20:23], s52 offen sc1
    s_waitcnt vmcnt(0)
    s_barrier
    v_mov_b32 v22, 0x7ffffff0
    v_cmp_eq_u32 vcc, 0, v0
    s_nop 1
    v_cndmask_b32 v22, v22, 0, vcc
    v_mov_b32 v23, 1
    buffer_atomic_add v23, v22, s[40:43], 0 offen sc1
K2_END:
    s_endpgm
.section .rodata,"a"
.p2align 6
.amdhsa_kernel k1_kernel
  .amdhsa_next_free_vgpr 212
  .amdhsa_next_free_sgpr 102
  .amdhsa_accum_offset 212
  .amdhsa_group_segment_fixed_size 0
  .amdhsa_kernarg_size 88
  .amdhsa_user_sgpr_count 2
  .amdhsa_user_sgpr_kernarg_segment_ptr 1
  .amdhsa_system_sgpr_workgroup_id_x 1
.end_amdhsa_kernel
.p2align 6
.amdhsa_kernel k2_kernel
  .amdhsa_next_free_vgpr 256
  .amdhsa_next_free_sgpr 102
  .amdhsa_accum_offset 256
  .amdhsa_group_segment_fixed_size 0
  .amdhsa_kernarg_size 88
  .amdhsa_user_sgpr_count 2
  .amdhsa_user_sgpr_kernarg_segment_ptr 1
  .amdhsa_system_sgpr_workgroup_id_x 1
.end_amdhsa_kernel
```
